```python
import torch

def _softmax(x, axis=-1):
    return torch.softmax(x, dim=axis)
def _gelu(x):
    return torch.nn.functional.gelu(x, approximate="tanh")
def _silu(x):
    return torch.nn.functional.silu(x)
def _sigmoid(x):
    return torch.sigmoid(x)
def _layernorm(x, axis=-1, eps=1e-5):
    m = x.mean(dim=axis, keepdim=True)
    v = x.var(dim=axis, keepdim=True, unbiased=False)
    return (x - m) / torch.sqrt(v + eps)
def _scatter_add(tgt, idx, src, axis=0):
    return tgt.clone().index_add_(axis, idx, src)
def _segment_sum(src, seg, n):
    out = torch.zeros((n,) + src.shape[1:], dtype=src.dtype)
    return out.index_add_(0, seg, src)
def _pad(x, pw):
    flat = tuple(v for pair in reversed(pw) for v in pair)
    return torch.nn.functional.pad(x, flat)

kernel_name = 'concat_heads__linear_kernel_hedgehog__spectral_fnet__prompt'

def setup_inputs():

    _w = (lambda a: (lambda t: t.to(torch.bfloat16) if t.is_floating_point() else t)(torch.as_tensor(a)))
    def _A_setup():
        B, S, D, H = 1, 2048, 512, 32
        Dh = D // H
        return {
            "x": _w((lambda *s: torch.randn(*s, dtype=torch.bfloat16) * 0.2)(B, S, D)),
            "wqkv": _w((lambda *s: torch.randn(*s, dtype=torch.bfloat16) * 1.6)(D, 3 * D)),
            "w_phi": _w((lambda *s: torch.randn(*s, dtype=torch.bfloat16) * 1.6)(H, Dh, Dh) * (Dh ** -0.5)),
            "wo": _w((lambda *s: torch.randn(*s, dtype=torch.bfloat16) * 0.8)(D, D)),
        }
    _A_in = _A_setup()

    def _B_setup():
        B, S, D = 1, 2048, 512
        ns = torch.arange(S)[:, None] * torch.arange(S)[None, :]
        nd = torch.arange(D)[:, None] * torch.arange(D)[None, :]
        Ws_re = torch.cos(-2.0 * torch.pi * ns / S).to(float)
        Ws_im = torch.sin(-2.0 * torch.pi * ns / S).to(float)
        Wd_re = torch.cos(-2.0 * torch.pi * nd / D).to(float)
        Wd_im = torch.sin(-2.0 * torch.pi * nd / D).to(float)
        return {
            "x": _w((lambda *s: torch.randn(*s, dtype=torch.bfloat16) * 0.05)(B, S, D)),
            "dft_seq_re": _w(Ws_re),
            "dft_seq_im": _w(Ws_im),
            "dft_hid_re": _w(Wd_re),
            "dft_hid_im": _w(Wd_im),
        }
    _B_in = _B_setup()

    return {
        "A_x": _A_in["x"],
        "A_wqkv": _A_in["wqkv"],
        "A_w_phi": _A_in["w_phi"],
        "A_wo": _A_in["wo"],
        "B_x": _B_in["x"],
        "B_dft_seq_re": _B_in["dft_seq_re"],
        "B_dft_seq_im": _B_in["dft_seq_im"],
        "B_dft_hid_re": _B_in["dft_hid_re"],
        "B_dft_hid_im": _B_in["dft_hid_im"],
    }

def reference(A_x, A_wqkv, A_w_phi, A_wo, B_x, B_dft_seq_re, B_dft_seq_im, B_dft_hid_re, B_dft_hid_im):
    def _A_ref(x, wqkv, w_phi, wo):
        B, S, D = x.shape
        H = 32; Dh = D // H
        qkv = (lambda x, *d: x.permute(*d))((x @ wqkv).reshape(B, S, 3, H, Dh), 2, 0, 3, 1, 4)
        q, k, v = qkv[0], qkv[1], qkv[2]
        pq = torch.einsum("bhsd,hdf->bhsf", q, w_phi)
        pk = torch.einsum("bhsd,hdf->bhsf", k, w_phi)
        phi_q = torch.concatenate([_softmax(pq, axis=-1), _softmax(-pq, axis=-1)], axis=-1)
        phi_k = torch.concatenate([_softmax(pk, axis=-1), _softmax(-pk, axis=-1)], axis=-1)
        kv = torch.einsum("bhsf,bhsd->bhfd", phi_k, v)
        z  = torch.einsum("bhsf->bhf", phi_k)
        num = torch.einsum("bhqf,bhfd->bhqd", phi_q, kv)
        den = torch.einsum("bhqf,bhf->bhq", phi_q, z)[..., None] + 1e-6
        o = num / den
        return (lambda x, *d: x.permute(*d))(o, 0, 2, 1, 3).reshape(B, S, D) @ wo

    def _B_ref(x, dft_seq_re, dft_seq_im, dft_hid_re, dft_hid_im):
        a = torch.einsum("bsd,ed->bse", x, dft_hid_re)
        b = torch.einsum("bsd,ed->bse", x, dft_hid_im)
        y = torch.einsum("ts,bse->bte", dft_seq_re, a) - torch.einsum("ts,bse->bte", dft_seq_im, b)
        return y

    a = _A_ref(A_x, A_wqkv, A_w_phi, A_wo)
    b = _B_ref(B_x, B_dft_seq_re, B_dft_seq_im, B_dft_hid_re, B_dft_hid_im)
    return torch.concatenate([a, b], axis=-1)
```

```asm
; @launch grid=(512,1,1) block=(256,1,1) lds=81920
.amdgcn_target "amdgcn-amd-amdhsa--gfx950"
.text
.globl concat_heads__linear_kernel_hedgehog__spectral_fnet__prompt_kernel
.p2align 8
.type concat_heads__linear_kernel_hedgehog__spectral_fnet__prompt_kernel,@function
concat_heads__linear_kernel_hedgehog__spectral_fnet__prompt_kernel:
    s_cmp_ge_u32 s2, 512
    s_cbranch_scc1 L_end
    s_load_dwordx16 s[72:87], s[0:1], 0
    s_load_dwordx8 s[88:95], s[0:1], 64
    v_and_b32 v1, 63, v0
    v_lshrrev_b32 v2, 6, v0
    s_nop 0
    v_readfirstlane_b32 s3, v2
    s_getpc_b64 s[96:97]
L_pc:
    s_lshr_b32 s4, s2, 3
    s_lshl_b32 s4, s4, 2
    s_add_u32 s4, s4, s3
    s_lshl_b32 s4, s4, 7
    s_min_u32 s4, s4, L_end-L_pc
    s_add_u32 s96, s96, s4
    s_addc_u32 s97, s97, 0
    v_mov_b32 v2, s96
    v_mov_b32 v3, s97
    s_mov_b64 exec, 1
    global_load_dword v123, v[2:3], off
    s_mov_b64 exec, -1
    s_lshl_b32 s60, s3, 10
    s_and_b32 s10, s3, 1
    s_lshr_b32 s11, s3, 1
    s_cmp_ge_u32 s2, 256
    s_cbranch_scc1 L_roleB
    s_setprio 2
    s_getreg_b32 s68, hwreg(HW_REG_XCC_ID, 0, 4)
    s_and_b32 s4, s2, 7
    s_lshr_b32 s5, s2, 3
    s_lshr_b32 s6, s4, 1
    s_lshl_b32 s6, s6, 2
    s_lshr_b32 s7, s5, 3
    s_add_u32 s61, s6, s7
    s_and_b32 s6, s4, 1
    s_lshl_b32 s6, s6, 3
    s_and_b32 s7, s5, 7
    s_add_u32 s62, s6, s7
    s_lshr_b32 s6, s5, 4
    s_lshl_b32 s61, s4, 1
    s_add_u32 s61, s61, s6
    s_and_b32 s62, s5, 15
    s_lshl_b32 s4, s61, 2
    s_add_u32 s4, s4, s3
    s_lshl_b32 s63, s4, 15
    s_lshl_b32 s64, s62, 6
    v_lshrrev_b32 v38, 3, v1
    s_lshl_b32 s6, s3, 3
    v_add_u32 v38, s6, v38
    v_and_b32 v39, 7, v1
    v_lshrrev_b32 v40, 4, v1
    s_lshl_b32 s6, s10, 2
    v_add_u32 v41, s6, v40
    v_xor_b32 v41, v41, v39
    v_lshlrev_b32 v41, 4, v41
    v_and_b32 v40, 1, v40
    v_lshlrev_b32 v40, 2, v40
    v_xor_b32 v40, v40, v39
    v_lshrrev_b32 v42, 2, v40
    v_and_b32 v43, 3, v40
    v_lshlrev_b32 v43, 4, v43
    v_mul_u32_u24 v44, 3072, v38
    v_add_u32 v44, v44, v43
    v_lshl_add_u32 v3, v42, 10, v44
    v_add_u32 v3, 1024, v3
    v_add_u32 v4, 98304, v3
    v_mul_u32_u24 v45, 196608, v42
    v_add_u32 v5, v44, v45
    v_add_u32 v6, 98304, v5
    v_lshlrev_b32 v44, 10, v38
    v_lshl_add_u32 v7, v40, 4, v44
    v_add_u32 v8, 32768, v7
    v_add_u32 v124, v44, v41
    v_add_u32 v125, 32768, v124
    s_waitcnt lgkmcnt(0)
    s_mov_b32 s12, s72
    s_mov_b32 s13, s73
    s_mov_b32 s14, 2097152
    s_mov_b32 s15, 0x00020000
    s_mov_b32 s16, s74
    s_mov_b32 s17, s75
    s_mov_b32 s18, 1572864
    s_mov_b32 s19, 0x00020000
    s_lshl_b32 s101, s61, 17
    s_add_u32 s73, s62, s61
    s_and_b32 s73, s73, 3
    s_lshl_b32 s72, s73, 1
    s_add_u32 s8, s72, 0
    s_and_b32 s8, s8, 7
    s_mul_i32 s8, s8, 196608
    s_add_u32 s8, s8, s64
    s_add_u32 m0, s60, 0
    s_nop 0
    buffer_load_dwordx4 v3, s[16:19], s8 offen lds
    s_add_u32 m0, s60, 4096
    s_nop 0
    buffer_load_dwordx4 v4, s[16:19], s8 offen lds
    s_add_u32 s8, s72, 0
    s_and_b32 s8, s8, 7
    s_mul_i32 s8, s8, 128
    s_add_u32 s8, s8, s101
    s_add_u32 m0, s60, 8192
    s_nop 0
    buffer_load_dwordx4 v124, s[12:15], s8 offen lds
    s_add_u32 m0, s60, 12288
    s_nop 0
    buffer_load_dwordx4 v125, s[12:15], s8 offen lds
    s_add_u32 s8, s8, 65536
    s_add_u32 m0, s60, 16384
    s_nop 0
    buffer_load_dwordx4 v124, s[12:15], s8 offen lds
    s_add_u32 m0, s60, 20480
    s_nop 0
    buffer_load_dwordx4 v125, s[12:15], s8 offen lds
    s_add_u32 s8, s72, 1
    s_and_b32 s8, s8, 7
    s_mul_i32 s8, s8, 196608
    s_add_u32 s8, s8, s64
    s_add_u32 m0, s60, 24576
    s_nop 0
    buffer_load_dwordx4 v3, s[16:19], s8 offen lds
    s_add_u32 m0, s60, 28672
    s_nop 0
    buffer_load_dwordx4 v4, s[16:19], s8 offen lds
    s_add_u32 s8, s72, 1
    s_and_b32 s8, s8, 7
    s_mul_i32 s8, s8, 128
    s_add_u32 s8, s8, s101
    s_add_u32 m0, s60, 32768
    s_nop 0
    buffer_load_dwordx4 v124, s[12:15], s8 offen lds
    s_add_u32 m0, s60, 36864
    s_nop 0
    buffer_load_dwordx4 v125, s[12:15], s8 offen lds
    s_add_u32 s8, s8, 65536
    s_add_u32 m0, s60, 40960
    s_nop 0
    buffer_load_dwordx4 v124, s[12:15], s8 offen lds
    s_add_u32 m0, s60, 45056
    s_nop 0
    buffer_load_dwordx4 v125, s[12:15], s8 offen lds
    s_mov_b32 s20, s76
    s_mov_b32 s21, s77
    s_mov_b32 s22, 16384
    s_mov_b32 s23, 0x00020000
    s_mov_b32 s24, s78
    s_mov_b32 s25, s79
    s_mov_b32 s26, 524288
    s_mov_b32 s27, 0x00020000
    s_mov_b32 s48, s90
    s_mov_b32 s49, s91
    s_mov_b32 s50, 4194304
    s_mov_b32 s51, 0x00020000
    s_mov_b32 s52, s92
    s_mov_b32 s53, s93
    s_mov_b32 s54, 256
    s_mov_b32 s55, 0x00020000
    s_mov_b32 s56, s94
    s_mov_b32 s57, s95
    s_mov_b32 s58, 16777216
    s_mov_b32 s59, 0x00020000
    s_or_b32 s4, s2, s3
    s_cmp_lg_u32 s4, 0
    s_cbranch_scc1 L_nononce
    s_memrealtime s[96:97]
    s_waitcnt lgkmcnt(0)
    s_or_b32 s96, s96, 1
    v_mov_b32 v38, s96
    v_mov_b32 v39, 0
    s_mov_b64 exec, 1
    buffer_store_dword v38, v39, s[52:55], 0 offen sc1
    s_mov_b64 exec, -1
    s_nop 1
L_nononce:
    v_lshrrev_b32 v38, 5, v1
    v_lshlrev_b32 v38, 3, v38
    v_bfe_u32 v39, v1, 2, 2
    v_add_u32 v38, v38, v39
    v_lshlrev_b32 v38, 7, v38
    v_bfe_u32 v40, v1, 4, 1
    v_lshlrev_b32 v40, 5, v40
    v_and_b32 v41, 3, v1
    v_lshl_add_u32 v40, v41, 3, v40
    v_bfe_u32 v41, v1, 3, 1
    v_lshlrev_b32 v41, 6, v41
    v_xor_b32 v40, v40, v41
    v_add_u32 v10, v38, v40
    v_xor_b32 v11, 64, v10
    v_and_b32 v13, 31, v1
    v_lshlrev_b32 v13, 7, v13
    v_lshrrev_b32 v38, 5, v1
    v_bfe_u32 v39, v1, 1, 3
    v_xor_b32 v38, v38, v39
    v_lshl_add_u32 v13, v38, 4, v13
    v_xor_b32 v14, 32, v13
    v_xor_b32 v15, 64, v13
    v_xor_b32 v16, 96, v13
    s_lshl_b32 s6, s3, 12
    v_add_u32 v13, s6, v13
    v_add_u32 v14, s6, v14
    v_add_u32 v15, s6, v15
    v_add_u32 v16, s6, v16
    v_lshlrev_b32 v40, 4, v1
    s_lshl_b32 s6, s62, 10
    s_add_u32 m0, s60, 73728
    s_nop 0
    buffer_load_dwordx4 v40, s[20:23], s6 offen lds
    s_lshl_b32 s6, s10, 6
    v_xor_b32 v12, s6, v10
    v_lshrrev_b32 v39, 5, v1
    v_and_b32 v38, 31, v1
    v_lshlrev_b32 v2, 10, v38
    v_lshl_add_u32 v2, v39, 4, v2
    v_lshlrev_b32 v17, 11, v38
    v_lshl_add_u32 v17, v39, 4, v17
    v_bfe_u32 v41, v1, 4, 1
    v_lshlrev_b32 v40, 9, v41
    v_lshl_add_u32 v40, v39, 7, v40
    v_bfe_u32 v41, v1, 2, 2
    v_lshl_add_u32 v40, v41, 5, v40
    v_and_b32 v41, 3, v1
    v_lshl_add_u32 v40, v41, 3, v40
    s_add_u32 s6, s60, 73728
    v_add_u32 v120, s6, v40
    v_lshlrev_b32 v42, 2, v39
    v_sub_u32 v42, v38, v42
    s_mov_b32 s4, 0x3f80
    s_mov_b32 s5, 0x3f800000
    v_mov_b32 v43, s4
    v_mov_b32 v44, s5
    v_cmp_eq_u32 vcc, 0, v42
    s_nop 1
    v_cndmask_b32 v30, 0, v43, vcc
    v_cmp_eq_u32 vcc, 1, v42
    s_nop 1
    v_cndmask_b32 v30, v30, v44, vcc
    v_cmp_eq_u32 vcc, 2, v42
    s_nop 1
    v_cndmask_b32 v31, 0, v43, vcc
    v_cmp_eq_u32 vcc, 3, v42
    s_nop 1
    v_cndmask_b32 v31, v31, v44, vcc
    v_cmp_eq_u32 vcc, 8, v42
    s_nop 1
    v_cndmask_b32 v32, 0, v43, vcc
    v_cmp_eq_u32 vcc, 9, v42
    s_nop 1
    v_cndmask_b32 v32, v32, v44, vcc
    v_cmp_eq_u32 vcc, 10, v42
    s_nop 1
    v_cndmask_b32 v33, 0, v43, vcc
    v_cmp_eq_u32 vcc, 11, v42
    s_nop 1
    v_cndmask_b32 v33, v33, v44, vcc
    v_cmp_eq_u32 vcc, 16, v42
    s_nop 1
    v_cndmask_b32 v34, 0, v43, vcc
    v_cmp_eq_u32 vcc, 17, v42
    s_nop 1
    v_cndmask_b32 v34, v34, v44, vcc
    v_cmp_eq_u32 vcc, 18, v42
    s_nop 1
    v_cndmask_b32 v35, 0, v43, vcc
    v_cmp_eq_u32 vcc, 19, v42
    s_nop 1
    v_cndmask_b32 v35, v35, v44, vcc
    v_cmp_eq_u32 vcc, 24, v42
    s_nop 1
    v_cndmask_b32 v36, 0, v43, vcc
    v_cmp_eq_u32 vcc, 25, v42
    s_nop 1
    v_cndmask_b32 v36, v36, v44, vcc
    v_cmp_eq_u32 vcc, 26, v42
    s_nop 1
    v_cndmask_b32 v37, 0, v43, vcc
    v_cmp_eq_u32 vcc, 27, v42
    s_nop 1
    v_cndmask_b32 v37, v37, v44, vcc
    v_lshrrev_b32 v42, 4, v1
    s_lshl_b32 s6, s3, 2
    v_add_u32 v42, s6, v42
    v_and_b32 v43, 15, v1
    v_min_u32 v44, 11, v1
    s_cmp_eq_u32 s3, 3
    s_cselect_b64 vcc, -1, 0
    v_cndmask_b32 v42, v42, v44, vcc
    v_cndmask_b32 v43, v43, 16, vcc
    v_cmp_le_u32 vcc, 6, v42
    s_nop 1
    v_cndmask_b32 v44, 0, 1, vcc
    v_mul_u32_u24 v45, 6, v44
    v_sub_u32 v45, v42, v45
    v_lshl_add_u32 v46, v42, 4, v43
    v_add_u32 v47, 192, v42
    s_cmp_eq_u32 s3, 3
    s_cselect_b64 vcc, -1, 0
    v_cndmask_b32 v46, v46, v47, vcc
    v_lshlrev_b32 v9, 4, v46
    v_lshl_add_u32 v46, v44, 4, v43
    v_and_b32 v46, 31, v46
    v_lshlrev_b32 v46, 4, v46
    v_lshl_add_u32 v46, v44, 12, v46
    v_add_u32 v46, 16384, v46
    v_mul_u32_u24 v45, 6, v45
    v_add_u32 v47, 0, v45
    v_lshrrev_b32 v43, 3, v47
    v_lshl_add_u32 v19, v43, 10, v46
    v_bfe_u32 v43, v47, 2, 1
    v_lshl_add_u32 v19, v43, 9, v19
    v_and_b32 v43, 3, v47
    v_lshl_add_u32 v19, v43, 2, v19
    v_add_u32 v47, 2, v45
    v_lshrrev_b32 v43, 3, v47
    v_lshl_add_u32 v20, v43, 10, v46
    v_bfe_u32 v43, v47, 2, 1
    v_lshl_add_u32 v20, v43, 9, v20
    v_and_b32 v43, 3, v47
    v_lshl_add_u32 v20, v43, 2, v20
    v_add_u32 v47, 4, v45
    v_lshrrev_b32 v43, 3, v47
    v_lshl_add_u32 v21, v43, 10, v46
    v_bfe_u32 v43, v47, 2, 1
    v_lshl_add_u32 v21, v43, 9, v21
    v_and_b32 v43, 3, v47
    v_lshl_add_u32 v21, v43, 2, v21
    s_lshl_b32 s5, s62, 16
    s_add_u32 s66, s5, 6291456
    s_lshl_b32 s5, s61, 12
    s_add_u32 s65, s66, s5
    s_lshl_b32 s67, s61, 7
    s_add_u32 s67, s67, 7340032
    s_lshl_b32 s4, s61, 2
    s_add_u32 s4, s4, s3
    s_lshl_b32 s4, s4, 6
    s_lshl_b32 s5, s62, 2
    s_add_u32 s69, s4, s5
    s_add_u32 s69, s69, 7344128
    s_lshr_b32 s6, s62, 3
    s_lshl_b32 s6, s6, 1
    s_lshl_b32 s4, s61, 2
    s_add_u32 s4, s4, s6
    s_lshl_b32 s70, s4, 6
    s_add_u32 s70, s70, 7344128
    s_lshl_b32 s98, s4, 15
    s_add_u32 s98, s98, 4194304
    s_add_u32 s4, s4, s11
    s_lshl_b32 s100, s4, 16
    s_and_b32 s5, s62, 7
    s_lshl_b32 s99, s5, 7
    s_add_u32 s100, s100, s99
    s_lshl_b32 s5, s10, 6
    s_add_u32 s100, s100, s5
    s_add_u32 s71, s63, s64
    s_add_u32 s71, s71, 4194304
    s_add_u32 s8, s72, 2
    s_and_b32 s8, s8, 7
    s_mul_i32 s8, s8, 196608
    s_add_u32 s8, s8, s64
    s_add_u32 m0, s60, 49152
    s_nop 0
    buffer_load_dwordx4 v3, s[16:19], s8 offen lds
    s_add_u32 m0, s60, 53248
    s_nop 0
    buffer_load_dwordx4 v4, s[16:19], s8 offen lds
    s_add_u32 s8, s72, 2
    s_and_b32 s8, s8, 7
    s_mul_i32 s8, s8, 128
    s_add_u32 s8, s8, s101
    s_add_u32 m0, s60, 57344
    s_nop 0
    buffer_load_dwordx4 v124, s[12:15], s8 offen lds
    s_add_u32 m0, s60, 61440
    s_nop 0
    buffer_load_dwordx4 v125, s[12:15], s8 offen lds
    s_add_u32 s8, s8, 65536
    s_add_u32 m0, s60, 65536
    s_nop 0
    buffer_load_dwordx4 v124, s[12:15], s8 offen lds
    s_add_u32 m0, s60, 69632
    s_nop 0
    buffer_load_dwordx4 v125, s[12:15], s8 offen lds
    s_waitcnt vmcnt(13)
    s_barrier
    ds_read_b128 a[0:3], v13 offset:8192
    ds_read_b64_tr_b16 v[80:81], v10 offset:0
    ds_read_b64_tr_b16 v[82:83], v10 offset:512
    ds_read_b64_tr_b16 v[84:85], v11 offset:0
    ds_read_b64_tr_b16 v[86:87], v11 offset:512
    ds_read_b128 a[4:7], v14 offset:8192
    ds_read_b64_tr_b16 v[88:89], v10 offset:2048
    ds_read_b64_tr_b16 v[90:91], v10 offset:2560
    ds_read_b64_tr_b16 v[92:93], v11 offset:2048
    ds_read_b64_tr_b16 v[94:95], v11 offset:2560
    ds_read_b128 a[8:11], v15 offset:8192
    ds_read_b64_tr_b16 v[96:97], v10 offset:4096
    ds_read_b64_tr_b16 v[98:99], v10 offset:4608
    ds_read_b64_tr_b16 v[100:101], v11 offset:4096
    ds_read_b64_tr_b16 v[102:103], v11 offset:4608
    ds_read_b128 a[12:15], v16 offset:8192
    ds_read_b64_tr_b16 v[104:105], v10 offset:6144
    ds_read_b64_tr_b16 v[106:107], v10 offset:6656
    ds_read_b64_tr_b16 v[108:109], v11 offset:6144
    ds_read_b64_tr_b16 v[110:111], v11 offset:6656
    s_waitcnt lgkmcnt(15)
    v_mfma_f32_32x32x16_bf16 v[48:63], v[80:83], a[0:3], 0
    v_mfma_f32_32x32x16_bf16 v[64:79], a[0:3], v[84:87], 0
    s_waitcnt lgkmcnt(10)
    v_mfma_f32_32x32x16_bf16 v[48:63], v[88:91], a[4:7], v[48:63]
    v_mfma_f32_32x32x16_bf16 v[64:79], a[4:7], v[92:95], v[64:79]
    s_waitcnt vmcnt(7) lgkmcnt(0)
    s_barrier
    ds_read_b128 a[16:19], v13 offset:32768
    ds_read_b64_tr_b16 v[80:81], v10 offset:24576
    ds_read_b64_tr_b16 v[82:83], v10 offset:25088
    ds_read_b64_tr_b16 v[84:85], v11 offset:24576
    ds_read_b64_tr_b16 v[86:87], v11 offset:25088
    v_mfma_f32_32x32x16_bf16 v[48:63], v[96:99], a[8:11], v[48:63]
    s_add_u32 s8, s72, 3
    s_and_b32 s8, s8, 7
    s_mul_i32 s8, s8, 196608
    s_add_u32 s8, s8, s64
    s_add_u32 m0, s60, 0
    s_nop 0
    buffer_load_dwordx4 v3, s[16:19], s8 offen lds
    ds_read_b128 a[20:23], v14 offset:32768
    ds_read_b64_tr_b16 v[88:89], v10 offset:26624
    ds_read_b64_tr_b16 v[90:91], v10 offset:27136
    ds_read_b64_tr_b16 v[92:93], v11 offset:26624
    ds_read_b64_tr_b16 v[94:95], v11 offset:27136
    v_mfma_f32_32x32x16_bf16 v[64:79], a[8:11], v[100:103], v[64:79]
    s_add_u32 m0, s60, 4096
    s_nop 0
    buffer_load_dwordx4 v4, s[16:19], s8 offen lds
    v_mfma_f32_32x32x16_bf16 v[48:63], v[104:107], a[12:15], v[48:63]
    s_add_u32 s8, s72, 3
    s_and_b32 s8, s8, 7
    s_mul_i32 s8, s8, 128
    s_add_u32 s8, s8, s101
    s_add_u32 m0, s60, 8192
    s_nop 0
    buffer_load_dwordx4 v124, s[12:15], s8 offen lds
    ds_read_b128 a[24:27], v15 offset:32768
    ds_read_b64_tr_b16 v[96:97], v10 offset:28672
    ds_read_b64_tr_b16 v[98:99], v10 offset:29184
    ds_read_b64_tr_b16 v[100:101], v11 offset:28672
    ds_read_b64_tr_b16 v[102:103], v11 offset:29184
    v_mfma_f32_32x32x16_bf16 v[64:79], a[12:15], v[108:111], v[64:79]
    s_add_u32 m0, s60, 12288
    s_nop 0
    buffer_load_dwordx4 v125, s[12:15], s8 offen lds
    ds_read_b128 a[28:31], v16 offset:32768
    ds_read_b64_tr_b16 v[104:105], v10 offset:30720
    ds_read_b64_tr_b16 v[106:107], v10 offset:31232
    ds_read_b64_tr_b16 v[108:109], v11 offset:30720
    ds_read_b64_tr_b16 v[110:111], v11 offset:31232
    s_waitcnt lgkmcnt(15)
    v_mfma_f32_32x32x16_bf16 v[48:63], v[80:83], a[16:19], v[48:63]
    s_add_u32 s8, s8, 65536
    s_add_u32 m0, s60, 16384
    s_nop 0
    buffer_load_dwordx4 v124, s[12:15], s8 offen lds
    v_mfma_f32_32x32x16_bf16 v[64:79], a[16:19], v[84:87], v[64:79]
    s_add_u32 m0, s60, 20480
    s_nop 0
    buffer_load_dwordx4 v125, s[12:15], s8 offen lds
    s_waitcnt lgkmcnt(10)
    v_mfma_f32_32x32x16_bf16 v[48:63], v[88:91], a[20:23], v[48:63]
    v_mfma_f32_32x32x16_bf16 v[64:79], a[20:23], v[92:95], v[64:79]
    s_waitcnt vmcnt(6) lgkmcnt(0)
    s_barrier
    ds_read_b128 a[32:35], v13 offset:57344
    ds_read_b64_tr_b16 v[80:81], v10 offset:49152
    ds_read_b64_tr_b16 v[82:83], v10 offset:49664
    ds_read_b64_tr_b16 v[84:85], v11 offset:49152
    ds_read_b64_tr_b16 v[86:87], v11 offset:49664
    v_mfma_f32_32x32x16_bf16 v[48:63], v[96:99], a[24:27], v[48:63]
    s_add_u32 s8, s72, 4
    s_and_b32 s8, s8, 7
    s_mul_i32 s8, s8, 196608
    s_add_u32 s8, s8, s64
    s_add_u32 m0, s60, 24576
    s_nop 0
    buffer_load_dwordx4 v3, s[16:19], s8 offen lds
    ds_read_b128 a[36:39], v14 offset:57344
    ds_read_b64_tr_b16 v[88:89], v10 offset:51200
    ds_read_b64_tr_b16 v[90:91], v10 offset:51712
    ds_read_b64_tr_b16 v[92:93], v11 offset:51200
    ds_read_b64_tr_b16 v[94:95], v11 offset:51712
    v_mfma_f32_32x32x16_bf16 v[64:79], a[24:27], v[100:103], v[64:79]
    s_add_u32 m0, s60, 28672
    s_nop 0
    buffer_load_dwordx4 v4, s[16:19], s8 offen lds
    v_mfma_f32_32x32x16_bf16 v[48:63], v[104:107], a[28:31], v[48:63]
    s_add_u32 s8, s72, 4
    s_and_b32 s8, s8, 7
    s_mul_i32 s8, s8, 128
    s_add_u32 s8, s8, s101
    s_add_u32 m0, s60, 32768
    s_nop 0
    buffer_load_dwordx4 v124, s[12:15], s8 offen lds
    ds_read_b128 a[40:43], v15 offset:57344
    ds_read_b64_tr_b16 v[96:97], v10 offset:53248
    ds_read_b64_tr_b16 v[98:99], v10 offset:53760
    ds_read_b64_tr_b16 v[100:101], v11 offset:53248
    ds_read_b64_tr_b16 v[102:103], v11 offset:53760
    v_mfma_f32_32x32x16_bf16 v[64:79], a[28:31], v[108:111], v[64:79]
    s_add_u32 m0, s60, 36864
    s_nop 0
    buffer_load_dwordx4 v125, s[12:15], s8 offen lds
    ds_read_b128 a[44:47], v16 offset:57344
    ds_read_b64_tr_b16 v[104:105], v10 offset:55296
    ds_read_b64_tr_b16 v[106:107], v10 offset:55808
    ds_read_b64_tr_b16 v[108:109], v11 offset:55296
    ds_read_b64_tr_b16 v[110:111], v11 offset:55808
    s_waitcnt lgkmcnt(15)
    v_mfma_f32_32x32x16_bf16 v[48:63], v[80:83], a[32:35], v[48:63]
    s_add_u32 s8, s8, 65536
    s_add_u32 m0, s60, 40960
    s_nop 0
    buffer_load_dwordx4 v124, s[12:15], s8 offen lds
    v_mfma_f32_32x32x16_bf16 v[64:79], a[32:35], v[84:87], v[64:79]
    s_add_u32 m0, s60, 45056
    s_nop 0
    buffer_load_dwordx4 v125, s[12:15], s8 offen lds
    s_waitcnt lgkmcnt(10)
    v_mfma_f32_32x32x16_bf16 v[48:63], v[88:91], a[36:39], v[48:63]
    v_mfma_f32_32x32x16_bf16 v[64:79], a[36:39], v[92:95], v[64:79]
    s_waitcnt vmcnt(6) lgkmcnt(0)
    s_barrier
    ds_read_b128 a[48:51], v13 offset:8192
    ds_read_b64_tr_b16 v[80:81], v10 offset:0
    ds_read_b64_tr_b16 v[82:83], v10 offset:512
    ds_read_b64_tr_b16 v[84:85], v11 offset:0
    ds_read_b64_tr_b16 v[86:87], v11 offset:512
    v_mfma_f32_32x32x16_bf16 v[48:63], v[96:99], a[40:43], v[48:63]
    s_add_u32 s8, s72, 5
    s_and_b32 s8, s8, 7
    s_mul_i32 s8, s8, 196608
    s_add_u32 s8, s8, s64
    s_add_u32 m0, s60, 49152
    s_nop 0
    buffer_load_dwordx4 v3, s[16:19], s8 offen lds
    ds_read_b128 a[52:55], v14 offset:8192
    ds_read_b64_tr_b16 v[88:89], v10 offset:2048
    ds_read_b64_tr_b16 v[90:91], v10 offset:2560
    ds_read_b64_tr_b16 v[92:93], v11 offset:2048
    ds_read_b64_tr_b16 v[94:95], v11 offset:2560
    v_mfma_f32_32x32x16_bf16 v[64:79], a[40:43], v[100:103], v[64:79]
    s_add_u32 m0, s60, 53248
    s_nop 0
    buffer_load_dwordx4 v4, s[16:19], s8 offen lds
    v_mfma_f32_32x32x16_bf16 v[48:63], v[104:107], a[44:47], v[48:63]
    s_add_u32 s8, s72, 5
    s_and_b32 s8, s8, 7
    s_mul_i32 s8, s8, 128
    s_add_u32 s8, s8, s101
    s_add_u32 m0, s60, 57344
    s_nop 0
    buffer_load_dwordx4 v124, s[12:15], s8 offen lds
    ds_read_b128 a[56:59], v15 offset:8192
    ds_read_b64_tr_b16 v[96:97], v10 offset:4096
    ds_read_b64_tr_b16 v[98:99], v10 offset:4608
    ds_read_b64_tr_b16 v[100:101], v11 offset:4096
    ds_read_b64_tr_b16 v[102:103], v11 offset:4608
    v_mfma_f32_32x32x16_bf16 v[64:79], a[44:47], v[108:111], v[64:79]
    s_add_u32 m0, s60, 61440
    s_nop 0
    buffer_load_dwordx4 v125, s[12:15], s8 offen lds
    ds_read_b128 a[60:63], v16 offset:8192
    ds_read_b64_tr_b16 v[104:105], v10 offset:6144
    ds_read_b64_tr_b16 v[106:107], v10 offset:6656
    ds_read_b64_tr_b16 v[108:109], v11 offset:6144
    ds_read_b64_tr_b16 v[110:111], v11 offset:6656
    s_waitcnt lgkmcnt(15)
    v_mfma_f32_32x32x16_bf16 v[48:63], v[80:83], a[48:51], v[48:63]
    s_add_u32 s8, s8, 65536
    s_add_u32 m0, s60, 65536
    s_nop 0
    buffer_load_dwordx4 v124, s[12:15], s8 offen lds
    v_mfma_f32_32x32x16_bf16 v[64:79], a[48:51], v[84:87], v[64:79]
    s_add_u32 m0, s60, 69632
    s_nop 0
    buffer_load_dwordx4 v125, s[12:15], s8 offen lds
    s_waitcnt lgkmcnt(10)
    v_mfma_f32_32x32x16_bf16 v[48:63], v[88:91], a[52:55], v[48:63]
    v_mfma_f32_32x32x16_bf16 v[64:79], a[52:55], v[92:95], v[64:79]
    s_waitcnt vmcnt(6) lgkmcnt(0)
    s_barrier
    ds_read_b128 a[64:67], v13 offset:32768
    ds_read_b64_tr_b16 v[80:81], v10 offset:24576
    ds_read_b64_tr_b16 v[82:83], v10 offset:25088
    ds_read_b64_tr_b16 v[84:85], v11 offset:24576
    ds_read_b64_tr_b16 v[86:87], v11 offset:25088
    v_mfma_f32_32x32x16_bf16 v[48:63], v[96:99], a[56:59], v[48:63]
    s_add_u32 s8, s72, 6
    s_and_b32 s8, s8, 7
    s_mul_i32 s8, s8, 196608
    s_add_u32 s8, s8, s64
    s_add_u32 m0, s60, 0
    s_nop 0
    buffer_load_dwordx4 v3, s[16:19], s8 offen lds
    ds_read_b128 a[68:71], v14 offset:32768
    ds_read_b64_tr_b16 v[88:89], v10 offset:26624
    ds_read_b64_tr_b16 v[90:91], v10 offset:27136
    ds_read_b64_tr_b16 v[92:93], v11 offset:26624
    ds_read_b64_tr_b16 v[94:95], v11 offset:27136
    v_mfma_f32_32x32x16_bf16 v[64:79], a[56:59], v[100:103], v[64:79]
    s_add_u32 m0, s60, 4096
    s_nop 0
    buffer_load_dwordx4 v4, s[16:19], s8 offen lds
    buffer_load_dword v18, off, s[52:55], 0 sc1
    v_mfma_f32_32x32x16_bf16 v[48:63], v[104:107], a[60:63], v[48:63]
    s_add_u32 s8, s72, 6
    s_and_b32 s8, s8, 7
    s_mul_i32 s8, s8, 128
    s_add_u32 s8, s8, s101
    s_add_u32 m0, s60, 8192
    s_nop 0
    buffer_load_dwordx4 v124, s[12:15], s8 offen lds
    ds_read_b128 a[72:75], v15 offset:32768
    ds_read_b64_tr_b16 v[96:97], v10 offset:28672
    ds_read_b64_tr_b16 v[98:99], v10 offset:29184
    ds_read_b64_tr_b16 v[100:101], v11 offset:28672
    ds_read_b64_tr_b16 v[102:103], v11 offset:29184
    v_mfma_f32_32x32x16_bf16 v[64:79], a[60:63], v[108:111], v[64:79]
    s_add_u32 m0, s60, 12288
    s_nop 0
    buffer_load_dwordx4 v125, s[12:15], s8 offen lds
    ds_read_b128 a[76:79], v16 offset:32768
    ds_read_b64_tr_b16 v[104:105], v10 offset:30720
    ds_read_b64_tr_b16 v[106:107], v10 offset:31232
    ds_read_b64_tr_b16 v[108:109], v11 offset:30720
    ds_read_b64_tr_b16 v[110:111], v11 offset:31232
    s_waitcnt lgkmcnt(15)
    v_mfma_f32_32x32x16_bf16 v[48:63], v[80:83], a[64:67], v[48:63]
    s_add_u32 s8, s8, 65536
    s_add_u32 m0, s60, 16384
    s_nop 0
    buffer_load_dwordx4 v124, s[12:15], s8 offen lds
    v_mfma_f32_32x32x16_bf16 v[64:79], a[64:67], v[84:87], v[64:79]
    s_add_u32 m0, s60, 20480
    s_nop 0
    buffer_load_dwordx4 v125, s[12:15], s8 offen lds
    s_waitcnt lgkmcnt(10)
    v_mfma_f32_32x32x16_bf16 v[48:63], v[88:91], a[68:71], v[48:63]
    v_mfma_f32_32x32x16_bf16 v[64:79], a[68:71], v[92:95], v[64:79]
    s_waitcnt vmcnt(7) lgkmcnt(0)
    s_barrier
    ds_read_b128 a[80:83], v13 offset:57344
    ds_read_b64_tr_b16 v[80:81], v10 offset:49152
    ds_read_b64_tr_b16 v[82:83], v10 offset:49664
    ds_read_b64_tr_b16 v[84:85], v11 offset:49152
    ds_read_b64_tr_b16 v[86:87], v11 offset:49664
    v_mfma_f32_32x32x16_bf16 v[48:63], v[96:99], a[72:75], v[48:63]
    s_add_u32 s8, s72, 7
    s_and_b32 s8, s8, 7
    s_mul_i32 s8, s8, 196608
    s_add_u32 s8, s8, s64
    s_add_u32 m0, s60, 24576
    s_nop 0
    buffer_load_dwordx4 v3, s[16:19], s8 offen lds
    ds_read_b128 a[84:87], v14 offset:57344
    ds_read_b64_tr_b16 v[88:89], v10 offset:51200
    ds_read_b64_tr_b16 v[90:91], v10 offset:51712
    ds_read_b64_tr_b16 v[92:93], v11 offset:51200
    ds_read_b64_tr_b16 v[94:95], v11 offset:51712
    v_mfma_f32_32x32x16_bf16 v[64:79], a[72:75], v[100:103], v[64:79]
    s_add_u32 m0, s60, 28672
    s_nop 0
    buffer_load_dwordx4 v4, s[16:19], s8 offen lds
    v_mfma_f32_32x32x16_bf16 v[48:63], v[104:107], a[76:79], v[48:63]
    s_add_u32 s8, s72, 7
    s_and_b32 s8, s8, 7
    s_mul_i32 s8, s8, 128
    s_add_u32 s8, s8, s101
    s_add_u32 m0, s60, 32768
    s_nop 0
    buffer_load_dwordx4 v124, s[12:15], s8 offen lds
    ds_read_b128 a[88:91], v15 offset:57344
    ds_read_b64_tr_b16 v[96:97], v10 offset:53248
    ds_read_b64_tr_b16 v[98:99], v10 offset:53760
    ds_read_b64_tr_b16 v[100:101], v11 offset:53248
    ds_read_b64_tr_b16 v[102:103], v11 offset:53760
    v_mfma_f32_32x32x16_bf16 v[64:79], a[76:79], v[108:111], v[64:79]
    s_add_u32 m0, s60, 36864
    s_nop 0
    buffer_load_dwordx4 v125, s[12:15], s8 offen lds
    ds_read_b128 a[92:95], v16 offset:57344
    ds_read_b64_tr_b16 v[104:105], v10 offset:55296
    ds_read_b64_tr_b16 v[106:107], v10 offset:55808
    ds_read_b64_tr_b16 v[108:109], v11 offset:55296
    ds_read_b64_tr_b16 v[110:111], v11 offset:55808
    ds_read_b64_tr_b16 v[112:113], v120
    ds_read_b64_tr_b16 v[114:115], v120 offset:256
    s_waitcnt lgkmcnt(15)
    v_mfma_f32_32x32x16_bf16 v[48:63], v[80:83], a[80:83], v[48:63]
    s_add_u32 s8, s8, 65536
    s_add_u32 m0, s60, 40960
    s_nop 0
    buffer_load_dwordx4 v124, s[12:15], s8 offen lds
    s_mov_b32 s7, 73728
    v_lshrrev_b32 v42, 4, v1
    s_lshl_b32 s6, s3, 2
    v_add_u32 v42, s6, v42
    v_and_b32 v43, 15, v1
    v_min_u32 v44, 11, v1
    s_cmp_eq_u32 s3, 3
    s_cselect_b64 vcc, -1, 0
    v_mfma_f32_32x32x16_bf16 v[64:79], a[80:83], v[84:87], v[64:79]
    s_add_u32 m0, s60, 45056
    s_nop 0
    buffer_load_dwordx4 v125, s[12:15], s8 offen lds
    v_cndmask_b32 v42, v42, v44, vcc
    v_cndmask_b32 v43, v43, 16, vcc
    v_cmp_le_u32 vcc, 6, v42
    s_nop 1
    v_cndmask_b32 v44, 0, 1, vcc
    v_mul_u32_u24 v45, 6, v44
    v_sub_u32 v45, v42, v45
    v_mul_u32_u24 v46, 17, v44
    s_waitcnt lgkmcnt(10)
    v_mfma_f32_32x32x16_bf16 v[48:63], v[88:91], a[84:87], v[48:63]
    v_add_u32 v46, v46, v43
    v_mul_u32_u24 v46, 80, v46
    v_mul_u32_u24 v47, 12, v45
    v_add3_u32 v3, v46, v47, s7
    v_min_u32 v42, 16, v38
    v_mul_u32_u24 v42, 80, v42
    v_lshl_add_u32 v42, v39, 3, v42
    v_mfma_f32_32x32x16_bf16 v[64:79], a[84:87], v[92:95], v[64:79]
    v_add_u32 v4, s7, v42
    v_subrev_u32 v43, 16, v38
    v_cmp_le_u32 vcc, 16, v38
    s_nop 1
    v_cndmask_b32 v43, 16, v43, vcc
    v_add_u32 v43, 17, v43
    v_mul_u32_u24 v43, 80, v43
    v_lshl_add_u32 v43, v39, 3, v43
    s_waitcnt vmcnt(6) lgkmcnt(0)
    s_barrier
    ds_read_b128 a[96:99], v13 offset:8192
    ds_read_b64_tr_b16 v[80:81], v10 offset:0
    ds_read_b64_tr_b16 v[82:83], v10 offset:512
    ds_read_b64_tr_b16 v[84:85], v11 offset:0
    ds_read_b64_tr_b16 v[86:87], v11 offset:512
    v_mfma_f32_32x32x16_bf16 v[48:63], v[96:99], a[88:91], v[48:63]
    s_add_u32 s8, s73, 0
    s_and_b32 s8, s8, 3
    s_mul_i32 s8, s8, 393216
    s_add_u32 s8, s8, s64
    s_add_u32 m0, s60, 49152
    s_nop 0
    buffer_load_dwordx4 v5, s[16:19], s8 offen lds
    ds_read_b128 a[100:103], v14 offset:8192
    ds_read_b64_tr_b16 v[88:89], v10 offset:2048
    ds_read_b64_tr_b16 v[90:91], v10 offset:2560
    ds_read_b64_tr_b16 v[92:93], v11 offset:2048
    ds_read_b64_tr_b16 v[94:95], v11 offset:2560
    v_mfma_f32_32x32x16_bf16 v[64:79], a[88:91], v[100:103], v[64:79]
    s_add_u32 m0, s60, 53248
    s_nop 0
    buffer_load_dwordx4 v6, s[16:19], s8 offen lds
    v_mfma_f32_32x32x16_bf16 v[48:63], v[104:107], a[92:95], v[48:63]
    s_add_u32 s8, s73, 1
    s_and_b32 s8, s8, 3
    s_mul_i32 s8, s8, 393216
    s_add_u32 s8, s8, s64
    s_add_u32 m0, s60, 57344
    s_nop 0
    buffer_load_dwordx4 v5, s[16:19], s8 offen lds
    ds_read_b128 a[104:107], v15 offset:8192
    ds_read_b64_tr_b16 v[96:97], v10 offset:4096
    ds_read_b64_tr_b16 v[98:99], v10 offset:4608
    ds_read_b64_tr_b16 v[100:101], v11 offset:4096
    ds_read_b64_tr_b16 v[102:103], v11 offset:4608
    v_mfma_f32_32x32x16_bf16 v[64:79], a[92:95], v[108:111], v[64:79]
    s_add_u32 m0, s60, 61440
    s_nop 0
    buffer_load_dwordx4 v6, s[16:19], s8 offen lds
    ds_read_b128 a[108:111], v16 offset:8192
    ds_read_b64_tr_b16 v[104:105], v10 offset:6144
    ds_read_b64_tr_b16 v[106:107], v10 offset:6656
    ds_read_b64_tr_b16 v[108:109], v11 offset:6144
    ds_read_b64_tr_b16 v[110:111], v11 offset:6656
    v_cmp_gt_u32 vcc, 16, v38
    s_nop 1
    v_cndmask_b32 v22, 0, v112, vcc
    v_cndmask_b32 v26, v112, 0, vcc
    v_cndmask_b32 v23, 0, v113, vcc
    v_cndmask_b32 v27, v113, 0, vcc
    v_cndmask_b32 v24, 0, v114, vcc
    v_cndmask_b32 v28, v114, 0, vcc
    v_cndmask_b32 v25, 0, v115, vcc
    v_cndmask_b32 v29, v115, 0, vcc
    s_waitcnt lgkmcnt(15)
    v_mfma_f32_32x32x16_bf16 v[48:63], v[80:83], a[96:99], v[48:63]
    v_add_u32 v126, s7, v43
    v_mfma_f32_32x32x16_bf16 v[64:79], a[96:99], v[84:87], v[64:79]
    s_waitcnt lgkmcnt(10)
    v_mfma_f32_32x32x16_bf16 v[48:63], v[88:91], a[100:103], v[48:63]
    v_mfma_f32_32x32x16_bf16 v[64:79], a[100:103], v[92:95], v[64:79]
    s_waitcnt vmcnt(4) lgkmcnt(0)
    s_barrier
    ds_read_b128 a[112:115], v13 offset:32768
    ds_read_b64_tr_b16 v[80:81], v10 offset:24576
    ds_read_b64_tr_b16 v[82:83], v10 offset:25088
    ds_read_b64_tr_b16 v[84:85], v11 offset:24576
    ds_read_b64_tr_b16 v[86:87], v11 offset:25088
    v_mfma_f32_32x32x16_bf16 v[48:63], v[96:99], a[104:107], v[48:63]
    s_add_u32 s8, s73, 2
    s_and_b32 s8, s8, 3
    s_mul_i32 s8, s8, 393216
    s_add_u32 s8, s8, s64
    s_add_u32 m0, s60, 0
    s_nop 0
    buffer_load_dwordx4 v5, s[16:19], s8 offen lds
    ds_read_b128 a[116:119], v14 offset:32768
    ds_read_b64_tr_b16 v[88:89], v10 offset:26624
    ds_read_b64_tr_b16 v[90:91], v10 offset:27136
    ds_read_b64_tr_b16 v[92:93], v11 offset:26624
    ds_read_b64_tr_b16 v[94:95], v11 offset:27136
    v_mfma_f32_32x32x16_bf16 v[64:79], a[104:107], v[100:103], v[64:79]
    s_add_u32 m0, s60, 4096
    s_nop 0
    buffer_load_dwordx4 v6, s[16:19], s8 offen lds
    v_mfma_f32_32x32x16_bf16 v[48:63], v[104:107], a[108:111], v[48:63]
    s_add_u32 s8, s73, 3
    s_and_b32 s8, s8, 3
    s_mul_i32 s8, s8, 393216
    s_add_u32 s8, s8, s64
    s_add_u32 m0, s60, 8192
    s_nop 0
    buffer_load_dwordx4 v5, s[16:19], s8 offen lds
    ds_read_b128 a[120:123], v15 offset:32768
    ds_read_b64_tr_b16 v[96:97], v10 offset:28672
    ds_read_b64_tr_b16 v[98:99], v10 offset:29184
    ds_read_b64_tr_b16 v[100:101], v11 offset:28672
    ds_read_b64_tr_b16 v[102:103], v11 offset:29184
    v_mfma_f32_32x32x16_bf16 v[64:79], a[108:111], v[108:111], v[64:79]
    s_add_u32 m0, s60, 12288
    s_nop 0
    buffer_load_dwordx4 v6, s[16:19], s8 offen lds
    ds_read_b128 a[124:127], v16 offset:32768
    ds_read_b64_tr_b16 v[104:105], v10 offset:30720
    ds_read_b64_tr_b16 v[106:107], v10 offset:31232
    ds_read_b64_tr_b16 v[108:109], v11 offset:30720
    ds_read_b64_tr_b16 v[110:111], v11 offset:31232
    s_waitcnt lgkmcnt(15)
    v_mfma_f32_32x32x16_bf16 v[48:63], v[80:83], a[112:115], v[48:63]
    v_mfma_f32_32x32x16_bf16 v[64:79], a[112:115], v[84:87], v[64:79]
    s_waitcnt lgkmcnt(10)
    v_mfma_f32_32x32x16_bf16 v[48:63], v[88:91], a[116:119], v[48:63]
    v_mfma_f32_32x32x16_bf16 v[64:79], a[116:119], v[92:95], v[64:79]
    s_waitcnt lgkmcnt(0)
    v_mfma_f32_32x32x16_bf16 v[48:63], v[96:99], a[120:123], v[48:63]
    v_mfma_f32_32x32x16_bf16 v[64:79], a[120:123], v[100:103], v[64:79]
    v_mfma_f32_32x32x16_bf16 v[48:63], v[104:107], a[124:127], v[48:63]
    v_mfma_f32_32x32x16_bf16 v[64:79], a[124:127], v[108:111], v[64:79]
    s_lshl_b32 s6, s3, 12
    v_subrev_u32 v13, s6, v13
    v_subrev_u32 v14, s6, v14
    v_subrev_u32 v15, s6, v15
    v_subrev_u32 v16, s6, v16
    s_nop 5
    v_cvt_pk_bf16_f32 v112, v48, v49
    v_cvt_pk_bf16_f32 v113, v50, v51
    v_cvt_pk_bf16_f32 v114, v52, v53
    v_cvt_pk_bf16_f32 v115, v54, v55
    v_cvt_pk_bf16_f32 v116, v56, v57
    v_cvt_pk_bf16_f32 v117, v58, v59
    v_cvt_pk_bf16_f32 v118, v60, v61
    v_cvt_pk_bf16_f32 v119, v62, v63
    v_mfma_f32_32x32x16_bf16 v[80:95], v[22:25], v[112:115], 0
    s_nop 0
    v_mfma_f32_32x32x16_bf16 v[80:95], v[26:29], v[116:119], v[80:95]
    s_mov_b32 s7, 0x3fb8aa3b
    s_nop 10
    v_max3_f32 v38, v80, v81, v82
    v_min3_f32 v39, v80, v81, v82
    v_max3_f32 v38, v38, v83, v84
    v_min3_f32 v39, v39, v83, v84
    v_max3_f32 v38, v38, v85, v86
    v_min3_f32 v39, v39, v85, v86
    v_max_f32 v38, v38, v87
    v_min_f32 v39, v39, v87
    v_max3_f32 v42, v88, v89, v90
    v_min3_f32 v43, v88, v89, v90
    v_max3_f32 v42, v42, v91, v92
    v_min3_f32 v43, v43, v91, v92
    v_max3_f32 v42, v42, v93, v94
    v_min3_f32 v43, v43, v93, v94
    v_max_f32 v42, v42, v95
    v_min_f32 v43, v43, v95
    v_mov_b32 v40, v38
    v_mov_b32 v41, v39
    v_mov_b32 v44, v42
    v_mov_b32 v45, v43
    v_permlane32_swap_b32 v38, v40
    v_permlane32_swap_b32 v39, v41
    v_permlane32_swap_b32 v42, v44
    v_permlane32_swap_b32 v43, v45
    v_max_f32 v38, v38, v40
    v_min_f32 v39, v39, v41
    v_mul_f32 v38, s7, v38
    v_mul_f32 v39, s7, v39
    v_max_f32 v42, v42, v44
    v_min_f32 v43, v43, v45
    v_mul_f32 v42, s7, v42
    v_mul_f32 v43, s7, v43
    v_fma_f32 v48, -v80, s7, v39
    v_fma_f32 v80, v80, s7, -v38
    v_fma_f32 v49, -v81, s7, v39
    v_fma_f32 v81, v81, s7, -v38
    v_fma_f32 v50, -v82, s7, v39
    v_fma_f32 v82, v82, s7, -v38
    v_fma_f32 v51, -v83, s7, v39
    v_fma_f32 v83, v83, s7, -v38
    v_fma_f32 v52, -v84, s7, v39
    v_fma_f32 v84, v84, s7, -v38
    v_fma_f32 v53, -v85, s7, v39
    v_fma_f32 v85, v85, s7, -v38
    v_fma_f32 v54, -v86, s7, v39
    v_fma_f32 v86, v86, s7, -v38
    v_fma_f32 v55, -v87, s7, v39
    v_fma_f32 v87, v87, s7, -v38
    v_fma_f32 v56, -v88, s7, v43
    v_fma_f32 v88, v88, s7, -v42
    v_fma_f32 v57, -v89, s7, v43
    v_fma_f32 v89, v89, s7, -v42
    v_fma_f32 v58, -v90, s7, v43
    v_fma_f32 v90, v90, s7, -v42
    v_fma_f32 v59, -v91, s7, v43
    v_fma_f32 v91, v91, s7, -v42
    v_fma_f32 v60, -v92, s7, v43
    v_fma_f32 v92, v92, s7, -v42
    v_fma_f32 v61, -v93, s7, v43
    v_fma_f32 v93, v93, s7, -v42
    v_fma_f32 v62, -v94, s7, v43
    v_fma_f32 v94, v94, s7, -v42
    v_fma_f32 v63, -v95, s7, v43
    v_fma_f32 v95, v95, s7, -v42
    v_exp_f32 v48, v48
    v_exp_f32 v80, v80
    v_exp_f32 v49, v49
    v_exp_f32 v81, v81
    v_exp_f32 v50, v50
    v_exp_f32 v82, v82
    v_exp_f32 v51, v51
    v_exp_f32 v83, v83
    v_exp_f32 v52, v52
    v_exp_f32 v84, v84
    v_exp_f32 v53, v53
    v_exp_f32 v85, v85
    v_exp_f32 v54, v54
    v_exp_f32 v86, v86
    v_exp_f32 v55, v55
    v_exp_f32 v87, v87
    v_exp_f32 v56, v56
    v_exp_f32 v88, v88
    v_exp_f32 v57, v57
    v_exp_f32 v89, v89
    v_exp_f32 v58, v58
    v_exp_f32 v90, v90
    v_exp_f32 v59, v59
    v_exp_f32 v91, v91
    v_exp_f32 v60, v60
    v_exp_f32 v92, v92
    v_exp_f32 v61, v61
    v_exp_f32 v93, v93
    v_exp_f32 v62, v62
    v_exp_f32 v94, v94
    v_exp_f32 v63, v63
    v_exp_f32 v95, v95
    v_add_f32 v38, v80, v81
    v_add_f32 v39, v48, v49
    v_add_f32 v38, v38, v82
    v_add_f32 v39, v39, v50
    v_add_f32 v38, v38, v83
    v_add_f32 v39, v39, v51
    v_add_f32 v38, v38, v84
    v_add_f32 v39, v39, v52
    v_add_f32 v38, v38, v85
    v_add_f32 v39, v39, v53
    v_add_f32 v38, v38, v86
    v_add_f32 v39, v39, v54
    v_add_f32 v38, v38, v87
    v_add_f32 v39, v39, v55
    v_mov_b32 v40, v38
    v_mov_b32 v41, v39
    v_add_f32 v42, v88, v89
    v_add_f32 v43, v56, v57
    v_add_f32 v42, v42, v90
    v_add_f32 v43, v43, v58
    v_add_f32 v42, v42, v91
    v_add_f32 v43, v43, v59
    v_add_f32 v42, v42, v92
    v_add_f32 v43, v43, v60
    v_add_f32 v42, v42, v93
    v_add_f32 v43, v43, v61
    v_add_f32 v42, v42, v94
    v_add_f32 v43, v43, v62
    v_add_f32 v42, v42, v95
    v_add_f32 v43, v43, v63
    v_mov_b32 v44, v42
    v_mov_b32 v45, v43
    v_permlane32_swap_b32 v38, v40
    v_permlane32_swap_b32 v39, v41
    v_permlane32_swap_b32 v42, v44
    v_permlane32_swap_b32 v43, v45
    v_add_f32 v38, v38, v40
    v_add_f32 v39, v39, v41
    v_rcp_f32 v38, v38
    v_rcp_f32 v39, v39
    v_add_f32 v42, v42, v44
    v_add_f32 v43, v43, v45
    v_rcp_f32 v42, v42
    v_rcp_f32 v43, v43
    v_mul_f32 v80, v80, v38
    v_mul_f32 v48, v48, v39
    v_mul_f32 v81, v81, v38
    v_mul_f32 v49, v49, v39
    v_mul_f32 v82, v82, v38
    v_mul_f32 v50, v50, v39
    v_mul_f32 v83, v83, v38
    v_mul_f32 v51, v51, v39
    v_mul_f32 v84, v84, v38
    v_mul_f32 v52, v52, v39
    v_mul_f32 v85, v85, v38
    v_mul_f32 v53, v53, v39
    v_mul_f32 v86, v86, v38
    v_mul_f32 v54, v54, v39
    v_mul_f32 v87, v87, v38
    v_mul_f32 v55, v55, v39
    v_cvt_pk_bf16_f32 v96, v80, v81
    v_cvt_pk_bf16_f32 v100, v48, v49
    v_cvt_pk_bf16_f32 v97, v82, v83
    v_cvt_pk_bf16_f32 v101, v50, v51
    v_cvt_pk_bf16_f32 v98, v84, v85
    v_cvt_pk_bf16_f32 v102, v52, v53
    v_cvt_pk_bf16_f32 v99, v86, v87
    v_cvt_pk_bf16_f32 v103, v54, v55
    v_mul_f32 v88, v88, v42
    v_mul_f32 v56, v56, v43
    v_mul_f32 v89, v89, v42
    v_mul_f32 v57, v57, v43
    v_mul_f32 v90, v90, v42
    v_mul_f32 v58, v58, v43
    v_mul_f32 v91, v91, v42
    v_mul_f32 v59, v59, v43
    v_mul_f32 v92, v92, v42
    v_mul_f32 v60, v60, v43
    v_mul_f32 v93, v93, v42
    v_mul_f32 v61, v61, v43
    v_mul_f32 v94, v94, v42
    v_mul_f32 v62, v62, v43
    v_mul_f32 v95, v95, v42
    v_mul_f32 v63, v63, v43
    v_cvt_pk_bf16_f32 v104, v88, v89
    v_cvt_pk_bf16_f32 v108, v56, v57
    v_cvt_pk_bf16_f32 v105, v90, v91
    v_cvt_pk_bf16_f32 v109, v58, v59
    v_cvt_pk_bf16_f32 v106, v92, v93
    v_cvt_pk_bf16_f32 v110, v60, v61
    v_cvt_pk_bf16_f32 v107, v94, v95
    v_cvt_pk_bf16_f32 v111, v62, v63
    v_mfma_f32_32x32x16_bf16 v[48:63], v[96:99], v[30:33], 0
    v_mfma_f32_32x32x16_bf16 v[48:63], v[100:103], v[34:37], v[48:63]
    v_mfma_f32_32x32x16_bf16 v[80:95], v[104:107], v[30:33], 0
    v_mfma_f32_32x32x16_bf16 v[80:95], v[108:111], v[34:37], v[80:95]
    v_cvt_pk_bf16_f32 v112, v64, v65
    v_cvt_pk_bf16_f32 v113, v66, v67
    v_cvt_pk_bf16_f32 v114, v68, v69
    v_cvt_pk_bf16_f32 v115, v70, v71
    v_cvt_pk_bf16_f32 v116, v72, v73
    v_cvt_pk_bf16_f32 v117, v74, v75
    v_cvt_pk_bf16_f32 v118, v76, v77
    v_cvt_pk_bf16_f32 v119, v78, v79
    s_mov_b32 s4, 0x3f803f80
    v_mov_b32 v38, s4
    v_and_b32 v39, 16, v1
    v_cmp_eq_u32 vcc, 0, v39
    s_nop 1
    v_cndmask_b32 v64, v38, v112, vcc
    v_cndmask_b32 v72, v112, v38, vcc
    v_cndmask_b32 v65, v38, v113, vcc
    v_cndmask_b32 v73, v113, v38, vcc
    v_cndmask_b32 v66, v38, v114, vcc
    v_cndmask_b32 v74, v114, v38, vcc
    v_cndmask_b32 v67, v38, v115, vcc
    v_cndmask_b32 v75, v115, v38, vcc
    v_cndmask_b32 v68, v38, v116, vcc
    v_cndmask_b32 v76, v116, v38, vcc
    v_cndmask_b32 v69, v38, v117, vcc
    v_cndmask_b32 v77, v117, v38, vcc
    v_cndmask_b32 v70, v38, v118, vcc
    v_cndmask_b32 v78, v118, v38, vcc
    v_cndmask_b32 v71, v38, v119, vcc
    v_cndmask_b32 v79, v119, v38, vcc
    v_cvt_pk_bf16_f32 v96, v48, v49
    v_cvt_pk_bf16_f32 v97, v50, v51
    v_cvt_pk_bf16_f32 v98, v52, v53
    v_cvt_pk_bf16_f32 v99, v54, v55
    v_cvt_pk_bf16_f32 v100, v56, v57
    v_cvt_pk_bf16_f32 v101, v58, v59
    v_cvt_pk_bf16_f32 v102, v60, v61
    v_cvt_pk_bf16_f32 v103, v62, v63
    v_cvt_pk_bf16_f32 v104, v80, v81
    v_cvt_pk_bf16_f32 v105, v82, v83
    v_cvt_pk_bf16_f32 v106, v84, v85
    v_cvt_pk_bf16_f32 v107, v86, v87
    v_cvt_pk_bf16_f32 v108, v88, v89
    v_cvt_pk_bf16_f32 v109, v90, v91
    v_cvt_pk_bf16_f32 v110, v92, v93
    v_cvt_pk_bf16_f32 v111, v94, v95
    v_mfma_f32_32x32x16_bf16 v[48:63], v[96:99], v[64:67], 0
    v_mfma_f32_32x32x16_bf16 v[48:63], v[100:103], v[68:71], v[48:63]
    v_mfma_f32_32x32x16_bf16 v[80:95], v[104:107], v[72:75], 0
    v_mfma_f32_32x32x16_bf16 v[80:95], v[108:111], v[76:79], v[80:95]
    v_lshlrev_b32 v38, 4, v1
    s_lshl_b32 s4, s3, 13
    v_add_u32 v39, s4, v38
    s_waitcnt vmcnt(0)
    s_barrier
    s_nop 4
    ds_write_b128 v39, v[48:51] offset:16384
    ds_write_b128 v39, v[52:55] offset:17408
    ds_write_b128 v39, v[56:59] offset:18432
    ds_write_b128 v39, v[60:63] offset:19456
    ds_write_b128 v39, v[80:83] offset:20480
    ds_write_b128 v39, v[84:87] offset:21504
    ds_write_b128 v39, v[88:91] offset:22528
    ds_write_b128 v39, v[92:95] offset:23552
    v_cmp_ne_u32 vcc, 0, v18
    s_cmp_eq_u64 vcc, exec
    s_cbranch_scc1 L_nonce_ok_A
    v_mov_b32 v38, 0
    s_mov_b32 s9, 0
L_nonce_A:
    buffer_load_dword v18, v38, s[52:55], 0 offen sc1
    s_add_u32 s9, s9, 1
    s_waitcnt vmcnt(0)
    v_cmp_ne_u32 vcc, 0, v18
    s_cmp_gt_u32 s9, 200000
    s_cbranch_scc1 L_nonce_A_x
    s_cmp_eq_u64 vcc, exec
    s_cbranch_scc0 L_nonce_A
L_nonce_A_x:
L_nonce_ok_A:
    s_waitcnt lgkmcnt(0)
    s_barrier
    ds_read_b64 v[80:81], v19 offset:0
    ds_read_b64 v[82:83], v20 offset:0
    ds_read_b64 v[84:85], v21 offset:0
    ds_read_b64 v[86:87], v19 offset:8192
    ds_read_b64 v[88:89], v20 offset:8192
    ds_read_b64 v[90:91], v21 offset:8192
    ds_read_b64 v[92:93], v19 offset:16384
    ds_read_b64 v[94:95], v20 offset:16384
    ds_read_b64 v[96:97], v21 offset:16384
    ds_read_b64 v[98:99], v19 offset:24576
    ds_read_b64 v[100:101], v20 offset:24576
    ds_read_b64 v[102:103], v21 offset:24576
    v_mov_b32 v40, s68
    v_mov_b32 v41, v18
    s_lshl_b32 s4, s62, 3
    s_add_u32 s4, s4, s67
    s_waitcnt lgkmcnt(6)
    v_add_f32 v80, v80, v86
    v_add_f32 v81, v81, v87
    v_add_f32 v82, v82, v88
    v_add_f32 v83, v83, v89
    v_add_f32 v84, v84, v90
    v_add_f32 v85, v85, v91
    s_waitcnt lgkmcnt(0)
    v_add_f32 v92, v92, v98
    v_add_f32 v93, v93, v99
    v_add_f32 v94, v94, v100
    v_add_f32 v95, v95, v101
    v_add_f32 v96, v96, v102
    v_add_f32 v97, v97, v103
    v_add_f32 v80, v80, v92
    v_add_f32 v81, v81, v93
    v_add_f32 v82, v82, v94
    v_add_f32 v83, v83, v95
    v_add_f32 v84, v84, v96
    v_add_f32 v85, v85, v97
    v_cvt_pk_bf16_f32 v112, v80, v81
    v_cvt_pk_bf16_f32 v113, v82, v83
    v_cvt_pk_bf16_f32 v114, v84, v85
    v_mov_b32 v115, v18
    buffer_store_dwordx4 v[112:115], v9, s[56:59], s65 offen sc1
    s_mov_b64 exec, 1
    buffer_store_dwordx2 v[40:41], off, s[56:59], s4 sc1
    s_mov_b64 exec, -1
    s_and_b32 s75, s62, 7
    ds_read_b64_tr_b16 v[80:81], v10 offset:49152
    ds_read_b64_tr_b16 v[82:83], v10 offset:49664
    ds_read_b64_tr_b16 v[84:85], v10 offset:51200
    ds_read_b64_tr_b16 v[86:87], v10 offset:51712
    ds_read_b64_tr_b16 v[88:89], v10 offset:53248
    ds_read_b64_tr_b16 v[90:91], v10 offset:53760
    ds_read_b64_tr_b16 v[92:93], v10 offset:55296
    ds_read_b64_tr_b16 v[94:95], v10 offset:55808
    ds_read_b64_tr_b16 v[96:97], v11 offset:49152
    ds_read_b64_tr_b16 v[98:99], v11 offset:49664
    ds_read_b64_tr_b16 v[100:101], v11 offset:51200
    ds_read_b64_tr_b16 v[102:103], v11 offset:51712
    ds_read_b64_tr_b16 v[104:105], v11 offset:53248
    ds_read_b64_tr_b16 v[106:107], v11 offset:53760
    ds_read_b64_tr_b16 v[108:109], v11 offset:55296
    ds_read_b64_tr_b16 v[110:111], v11 offset:55808
    s_barrier
    v_and_b32 v19, 15, v1
    v_lshlrev_b32 v19, 3, v19
    s_waitcnt lgkmcnt(14)
    v_mfma_f32_32x32x16_bf16 v[48:63], v[80:83], a[0:3], 0
    ds_read_b64_tr_b16 v[80:81], v10 offset:57344
    ds_read_b64_tr_b16 v[82:83], v10 offset:57856
    s_add_u32 s8, s75, 0
    s_and_b32 s8, s8, 7
    s_mul_i32 s8, s8, 65536
    s_add_u32 s8, s8, s99
    s_add_u32 m0, s60, 16384
    s_nop 0
    buffer_load_dwordx4 v7, s[24:27], s8 offen lds
    s_waitcnt lgkmcnt(14)
    v_mfma_f32_32x32x16_bf16 v[48:63], v[84:87], a[4:7], v[48:63]
    ds_read_b64_tr_b16 v[84:85], v10 offset:59392
    ds_read_b64_tr_b16 v[86:87], v10 offset:59904
    s_waitcnt lgkmcnt(14)
    v_mfma_f32_32x32x16_bf16 v[48:63], v[88:91], a[8:11], v[48:63]
    ds_read_b64_tr_b16 v[88:89], v10 offset:61440
    ds_read_b64_tr_b16 v[90:91], v10 offset:61952
    s_waitcnt lgkmcnt(14)
    v_mfma_f32_32x32x16_bf16 v[48:63], v[92:95], a[12:15], v[48:63]
    ds_read_b64_tr_b16 v[92:93], v10 offset:63488
    ds_read_b64_tr_b16 v[94:95], v10 offset:64000
    s_waitcnt lgkmcnt(14)
    v_mfma_f32_32x32x16_bf16 v[48:63], v[96:99], a[16:19], v[48:63]
    ds_read_b64_tr_b16 v[96:97], v11 offset:57344
    ds_read_b64_tr_b16 v[98:99], v11 offset:57856
    s_add_u32 m0, s60, 20480
    s_nop 0
    buffer_load_dwordx4 v8, s[24:27], s8 offen lds
    s_waitcnt lgkmcnt(14)
    v_mfma_f32_32x32x16_bf16 v[48:63], v[100:103], a[20:23], v[48:63]
    ds_read_b64_tr_b16 v[100:101], v11 offset:59392
    ds_read_b64_tr_b16 v[102:103], v11 offset:59904
    s_waitcnt lgkmcnt(14)
    v_mfma_f32_32x32x16_bf16 v[48:63], v[104:107], a[24:27], v[48:63]
    ds_read_b64_tr_b16 v[104:105], v11 offset:61440
    ds_read_b64_tr_b16 v[106:107], v11 offset:61952
    s_waitcnt lgkmcnt(14)
    v_mfma_f32_32x32x16_bf16 v[48:63], v[108:111], a[28:31], v[48:63]
    ds_read_b64_tr_b16 v[108:109], v11 offset:63488
    ds_read_b64_tr_b16 v[110:111], v11 offset:64000
    s_waitcnt lgkmcnt(14)
    v_mfma_f32_32x32x16_bf16 v[48:63], v[80:83], a[32:35], v[48:63]
    ds_read_b64_tr_b16 v[80:81], v10 offset:0
    ds_read_b64_tr_b16 v[82:83], v10 offset:512
    s_add_u32 s8, s75, 1
    s_and_b32 s8, s8, 7
    s_mul_i32 s8, s8, 65536
    s_add_u32 s8, s8, s99
    s_add_u32 m0, s60, 24576
    s_nop 0
    buffer_load_dwordx4 v7, s[24:27], s8 offen lds
    s_waitcnt lgkmcnt(14)
    v_mfma_f32_32x32x16_bf16 v[48:63], v[84:87], a[36:39], v[48:63]
    ds_read_b64_tr_b16 v[84:85], v10 offset:2048
    ds_read_b64_tr_b16 v[86:87], v10 offset:2560
    s_waitcnt lgkmcnt(14)
    v_mfma_f32_32x32x16_bf16 v[48:63], v[88:91], a[40:43], v[48:63]
    ds_read_b64_tr_b16 v[88:89], v10 offset:4096
    ds_read_b64_tr_b16 v[90:91], v10 offset:4608
    s_waitcnt lgkmcnt(14)
    v_mfma_f32_32x32x16_bf16 v[48:63], v[92:95], a[44:47], v[48:63]
    ds_read_b64_tr_b16 v[92:93], v10 offset:6144
    ds_read_b64_tr_b16 v[94:95], v10 offset:6656
    s_waitcnt lgkmcnt(14)
    v_mfma_f32_32x32x16_bf16 v[48:63], v[96:99], a[48:51], v[48:63]
    ds_read_b64_tr_b16 v[96:97], v11 offset:0
    ds_read_b64_tr_b16 v[98:99], v11 offset:512
    s_add_u32 m0, s60, 28672
    s_nop 0
    buffer_load_dwordx4 v8, s[24:27], s8 offen lds
    s_waitcnt lgkmcnt(14)
    v_mfma_f32_32x32x16_bf16 v[48:63], v[100:103], a[52:55], v[48:63]
    ds_read_b64_tr_b16 v[100:101], v11 offset:2048
    ds_read_b64_tr_b16 v[102:103], v11 offset:2560
    s_waitcnt lgkmcnt(14)
    v_mfma_f32_32x32x16_bf16 v[48:63], v[104:107], a[56:59], v[48:63]
    ds_read_b64_tr_b16 v[104:105], v11 offset:4096
    ds_read_b64_tr_b16 v[106:107], v11 offset:4608
    s_waitcnt lgkmcnt(14)
    v_mfma_f32_32x32x16_bf16 v[48:63], v[108:111], a[60:63], v[48:63]
    ds_read_b64_tr_b16 v[108:109], v11 offset:6144
    ds_read_b64_tr_b16 v[110:111], v11 offset:6656
    s_waitcnt lgkmcnt(14)
    v_mfma_f32_32x32x16_bf16 v[48:63], v[80:83], a[64:67], v[48:63]
    ds_read_b64_tr_b16 v[80:81], v10 offset:8192
    ds_read_b64_tr_b16 v[82:83], v10 offset:8704
    s_add_u32 s8, s75, 2
    s_and_b32 s8, s8, 7
    s_mul_i32 s8, s8, 65536
    s_add_u32 s8, s8, s99
    s_add_u32 m0, s60, 32768
    s_nop 0
    buffer_load_dwordx4 v7, s[24:27], s8 offen lds
    s_waitcnt lgkmcnt(14)
    v_mfma_f32_32x32x16_bf16 v[48:63], v[84:87], a[68:71], v[48:63]
    ds_read_b64_tr_b16 v[84:85], v10 offset:10240
    ds_read_b64_tr_b16 v[86:87], v10 offset:10752
    s_waitcnt lgkmcnt(14)
    v_mfma_f32_32x32x16_bf16 v[48:63], v[88:91], a[72:75], v[48:63]
    ds_read_b64_tr_b16 v[88:89], v10 offset:12288
    ds_read_b64_tr_b16 v[90:91], v10 offset:12800
    s_waitcnt lgkmcnt(14)
    v_mfma_f32_32x32x16_bf16 v[48:63], v[92:95], a[76:79], v[48:63]
    ds_read_b64_tr_b16 v[92:93], v10 offset:14336
    ds_read_b64_tr_b16 v[94:95], v10 offset:14848
    s_waitcnt lgkmcnt(14)
    v_mfma_f32_32x32x16_bf16 v[48:63], v[96:99], a[80:83], v[48:63]
    ds_read_b64_tr_b16 v[96:97], v11 offset:8192
    ds_read_b64_tr_b16 v[98:99], v11 offset:8704
    s_add_u32 m0, s60, 36864
    s_nop 0
    buffer_load_dwordx4 v8, s[24:27], s8 offen lds
    s_waitcnt lgkmcnt(14)
    v_mfma_f32_32x32x16_bf16 v[48:63], v[100:103], a[84:87], v[48:63]
    ds_read_b64_tr_b16 v[100:101], v11 offset:10240
    ds_read_b64_tr_b16 v[102:103], v11 offset:10752
    s_waitcnt lgkmcnt(14)
    v_mfma_f32_32x32x16_bf16 v[48:63], v[104:107], a[88:91], v[48:63]
    ds_read_b64_tr_b16 v[104:105], v11 offset:12288
    ds_read_b64_tr_b16 v[106:107], v11 offset:12800
    s_waitcnt lgkmcnt(14)
    v_mfma_f32_32x32x16_bf16 v[48:63], v[108:111], a[92:95], v[48:63]
    ds_read_b64_tr_b16 v[108:109], v11 offset:14336
    ds_read_b64_tr_b16 v[110:111], v11 offset:14848
    s_waitcnt lgkmcnt(14)
    v_mfma_f32_32x32x16_bf16 v[48:63], v[80:83], a[96:99], v[48:63]
    s_add_u32 s8, s75, 3
    s_and_b32 s8, s8, 7
    s_mul_i32 s8, s8, 65536
    s_add_u32 s8, s8, s99
    s_add_u32 m0, s60, 40960
    s_nop 0
    buffer_load_dwordx4 v7, s[24:27], s8 offen lds
    s_waitcnt lgkmcnt(12)
    v_mfma_f32_32x32x16_bf16 v[48:63], v[84:87], a[100:103], v[48:63]
    s_waitcnt lgkmcnt(10)
    v_mfma_f32_32x32x16_bf16 v[48:63], v[88:91], a[104:107], v[48:63]
    s_waitcnt lgkmcnt(8)
    v_mfma_f32_32x32x16_bf16 v[48:63], v[92:95], a[108:111], v[48:63]
    s_waitcnt lgkmcnt(6)
    v_mfma_f32_32x32x16_bf16 v[48:63], v[96:99], a[112:115], v[48:63]
    s_add_u32 m0, s60, 45056
    s_nop 0
    buffer_load_dwordx4 v8, s[24:27], s8 offen lds
    s_waitcnt lgkmcnt(4)
    v_mfma_f32_32x32x16_bf16 v[48:63], v[100:103], a[116:119], v[48:63]
    s_waitcnt lgkmcnt(2)
    v_mfma_f32_32x32x16_bf16 v[48:63], v[104:107], a[120:123], v[48:63]
    s_waitcnt lgkmcnt(0)
    v_mfma_f32_32x32x16_bf16 v[48:63], v[108:111], a[124:127], v[48:63]
    s_barrier
    s_lshl_b32 s6, s11, 12
    v_add_u32 v13, s6, v13
    v_add_u32 v14, s6, v14
    v_add_u32 v15, s6, v15
    v_add_u32 v16, s6, v16
    s_nop 5
    v_cvt_pk_bf16_f32 v112, v48, v49
    v_cvt_pk_bf16_f32 v113, v50, v51
    v_cvt_pk_bf16_f32 v114, v52, v53
    v_cvt_pk_bf16_f32 v115, v54, v55
    v_cvt_pk_bf16_f32 v116, v56, v57
    v_cvt_pk_bf16_f32 v117, v58, v59
    v_cvt_pk_bf16_f32 v118, v60, v61
    s_add_u32 s8, s75, 4
    s_and_b32 s8, s8, 7
    s_mul_i32 s8, s8, 65536
    s_add_u32 s8, s8, s99
    s_add_u32 m0, s60, 49152
    s_nop 0
    buffer_load_dwordx4 v7, s[24:27], s8 offen lds
    v_cvt_pk_bf16_f32 v119, v62, v63
    v_mfma_f32_32x32x16_bf16 v[80:95], v[22:25], v[112:115], 0
    s_nop 0
    v_mfma_f32_32x32x16_bf16 v[80:95], v[26:29], v[116:119], v[80:95]
    s_mov_b32 s7, 0x3fb8aa3b
    s_nop 10
    v_max3_f32 v38, v80, v81, v82
    v_min3_f32 v39, v80, v81, v82
    v_max3_f32 v38, v38, v83, v84
    v_min3_f32 v39, v39, v83, v84
    v_max3_f32 v38, v38, v85, v86
    v_min3_f32 v39, v39, v85, v86
    v_max_f32 v38, v38, v87
    v_min_f32 v39, v39, v87
    v_max3_f32 v42, v88, v89, v90
    v_min3_f32 v43, v88, v89, v90
    v_max3_f32 v42, v42, v91, v92
    v_min3_f32 v43, v43, v91, v92
    v_max3_f32 v42, v42, v93, v94
    v_min3_f32 v43, v43, v93, v94
    v_max_f32 v42, v42, v95
    v_min_f32 v43, v43, v95
    v_mov_b32 v40, v38
    v_mov_b32 v41, v39
    v_mov_b32 v44, v42
    v_mov_b32 v45, v43
    v_permlane32_swap_b32 v38, v40
    s_add_u32 m0, s60, 53248
    s_nop 0
    buffer_load_dwordx4 v8, s[24:27], s8 offen lds
    v_permlane32_swap_b32 v39, v41
    v_permlane32_swap_b32 v42, v44
    v_permlane32_swap_b32 v43, v45
    v_max_f32 v38, v38, v40
    v_min_f32 v39, v39, v41
    v_mul_f32 v38, s7, v38
    v_mul_f32 v39, s7, v39
    v_max_f32 v42, v42, v44
    v_min_f32 v43, v43, v45
    v_mul_f32 v42, s7, v42
    v_mul_f32 v43, s7, v43
    v_fma_f32 v48, -v80, s7, v39
    v_fma_f32 v80, v80, s7, -v38
    v_fma_f32 v49, -v81, s7, v39
    v_fma_f32 v81, v81, s7, -v38
    v_fma_f32 v50, -v82, s7, v39
    v_fma_f32 v82, v82, s7, -v38
    v_fma_f32 v51, -v83, s7, v39
    v_fma_f32 v83, v83, s7, -v38
    v_fma_f32 v52, -v84, s7, v39
    v_fma_f32 v84, v84, s7, -v38
    v_fma_f32 v53, -v85, s7, v39
    v_fma_f32 v85, v85, s7, -v38
    v_fma_f32 v54, -v86, s7, v39
    v_fma_f32 v86, v86, s7, -v38
    v_fma_f32 v55, -v87, s7, v39
    s_add_u32 s8, s75, 5
    s_and_b32 s8, s8, 7
    s_mul_i32 s8, s8, 65536
    s_add_u32 s8, s8, s99
    s_add_u32 m0, s60, 57344
    s_nop 0
    buffer_load_dwordx4 v7, s[24:27], s8 offen lds
    v_fma_f32 v87, v87, s7, -v38
    v_fma_f32 v56, -v88, s7, v43
    v_fma_f32 v88, v88, s7, -v42
    v_fma_f32 v57, -v89, s7, v43
    v_fma_f32 v89, v89, s7, -v42
    v_fma_f32 v58, -v90, s7, v43
    v_fma_f32 v90, v90, s7, -v42
    v_fma_f32 v59, -v91, s7, v43
    v_fma_f32 v91, v91, s7, -v42
    v_fma_f32 v60, -v92, s7, v43
    v_fma_f32 v92, v92, s7, -v42
    v_fma_f32 v61, -v93, s7, v43
    v_fma_f32 v93, v93, s7, -v42
    v_fma_f32 v62, -v94, s7, v43
    v_fma_f32 v94, v94, s7, -v42
    v_fma_f32 v63, -v95, s7, v43
    v_fma_f32 v95, v95, s7, -v42
    v_exp_f32 v48, v48
    v_exp_f32 v80, v80
    v_exp_f32 v49, v49
    v_exp_f32 v81, v81
    v_exp_f32 v50, v50
    v_exp_f32 v82, v82
    v_exp_f32 v51, v51
    v_exp_f32 v83, v83
    v_exp_f32 v52, v52
    s_add_u32 m0, s60, 61440
    s_nop 0
    buffer_load_dwordx4 v8, s[24:27], s8 offen lds
    v_exp_f32 v84, v84
    v_exp_f32 v53, v53
    v_exp_f32 v85, v85
    v_exp_f32 v54, v54
    v_exp_f32 v86, v86
    v_exp_f32 v55, v55
    v_exp_f32 v87, v87
    v_exp_f32 v56, v56
    v_exp_f32 v88, v88
    v_exp_f32 v57, v57
    v_exp_f32 v89, v89
    v_exp_f32 v58, v58
    v_exp_f32 v90, v90
    v_exp_f32 v59, v59
    v_exp_f32 v91, v91
    v_exp_f32 v60, v60
    v_exp_f32 v92, v92
    v_exp_f32 v61, v61
    v_exp_f32 v93, v93
    v_exp_f32 v62, v62
    v_exp_f32 v94, v94
    v_exp_f32 v63, v63
    v_exp_f32 v95, v95
    v_add_f32 v38, v80, v81
    v_add_f32 v39, v48, v49
    v_add_f32 v38, v38, v82
    s_add_u32 s8, s75, 6
    s_and_b32 s8, s8, 7
    s_mul_i32 s8, s8, 65536
    s_add_u32 s8, s8, s99
    s_add_u32 m0, s60, 0
    s_nop 0
    buffer_load_dwordx4 v7, s[24:27], s8 offen lds
    v_add_f32 v39, v39, v50
    v_add_f32 v38, v38, v83
    v_add_f32 v39, v39, v51
    v_add_f32 v38, v38, v84
    v_add_f32 v39, v39, v52
    v_add_f32 v38, v38, v85
    v_add_f32 v39, v39, v53
    v_add_f32 v38, v38, v86
    v_add_f32 v39, v39, v54
    v_add_f32 v38, v38, v87
    v_add_f32 v39, v39, v55
    v_mov_b32 v40, v38
    v_mov_b32 v41, v39
    v_add_f32 v42, v88, v89
    v_add_f32 v43, v56, v57
    v_add_f32 v42, v42, v90
    v_add_f32 v43, v43, v58
    v_add_f32 v42, v42, v91
    v_add_f32 v43, v43, v59
    v_add_f32 v42, v42, v92
    v_add_f32 v43, v43, v60
    v_add_f32 v42, v42, v93
    v_add_f32 v43, v43, v61
    v_add_f32 v42, v42, v94
    v_add_f32 v43, v43, v62
    v_add_f32 v42, v42, v95
    s_add_u32 m0, s60, 4096
    s_nop 0
    buffer_load_dwordx4 v8, s[24:27], s8 offen lds
    v_add_f32 v43, v43, v63
    v_mov_b32 v44, v42
    v_mov_b32 v45, v43
    v_permlane32_swap_b32 v38, v40
    v_permlane32_swap_b32 v39, v41
    v_permlane32_swap_b32 v42, v44
    v_permlane32_swap_b32 v43, v45
    v_add_f32 v38, v38, v40
    v_add_f32 v39, v39, v41
    v_rcp_f32 v38, v38
    v_rcp_f32 v39, v39
    v_add_f32 v42, v42, v44
    v_add_f32 v43, v43, v45
    v_rcp_f32 v42, v42
    v_rcp_f32 v43, v43
    v_mul_f32 v80, v80, v38
    v_mul_f32 v48, v48, v39
    v_mul_f32 v81, v81, v38
    v_mul_f32 v49, v49, v39
    v_mul_f32 v82, v82, v38
    v_mul_f32 v50, v50, v39
    v_mul_f32 v83, v83, v38
    v_mul_f32 v51, v51, v39
    v_mul_f32 v84, v84, v38
    v_mul_f32 v52, v52, v39
    v_mul_f32 v85, v85, v38
    s_add_u32 s8, s75, 7
    s_and_b32 s8, s8, 7
    s_mul_i32 s8, s8, 65536
    s_add_u32 s8, s8, s99
    s_add_u32 m0, s60, 8192
    s_nop 0
    buffer_load_dwordx4 v7, s[24:27], s8 offen lds
    v_mul_f32 v53, v53, v39
    v_mul_f32 v86, v86, v38
    v_mul_f32 v54, v54, v39
    v_mul_f32 v87, v87, v38
    v_mul_f32 v55, v55, v39
    v_cvt_pk_bf16_f32 v64, v80, v81
    v_cvt_pk_bf16_f32 v68, v48, v49
    v_cvt_pk_bf16_f32 v65, v82, v83
    v_cvt_pk_bf16_f32 v69, v50, v51
    v_cvt_pk_bf16_f32 v66, v84, v85
    v_cvt_pk_bf16_f32 v70, v52, v53
    v_cvt_pk_bf16_f32 v67, v86, v87
    v_cvt_pk_bf16_f32 v71, v54, v55
    v_mul_f32 v88, v88, v42
    v_mul_f32 v56, v56, v43
    v_mul_f32 v89, v89, v42
    v_mul_f32 v57, v57, v43
    v_mul_f32 v90, v90, v42
    v_mul_f32 v58, v58, v43
    v_mul_f32 v91, v91, v42
    v_mul_f32 v59, v59, v43
    v_mul_f32 v92, v92, v42
    v_mul_f32 v60, v60, v43
    v_mul_f32 v93, v93, v42
    v_mul_f32 v61, v61, v43
    v_mul_f32 v94, v94, v42
    s_add_u32 m0, s60, 12288
    s_nop 0
    buffer_load_dwordx4 v8, s[24:27], s8 offen lds
    v_mul_f32 v62, v62, v43
    v_mul_f32 v95, v95, v42
    v_mul_f32 v63, v63, v43
    v_cvt_pk_bf16_f32 v72, v88, v89
    v_cvt_pk_bf16_f32 v76, v56, v57
    v_cvt_pk_bf16_f32 v73, v90, v91
    v_cvt_pk_bf16_f32 v77, v58, v59
    v_cvt_pk_bf16_f32 v74, v92, v93
    v_cvt_pk_bf16_f32 v78, v60, v61
    v_cvt_pk_bf16_f32 v75, v94, v95
    v_cvt_pk_bf16_f32 v79, v62, v63
    buffer_load_dwordx2 v[20:21], v19, s[56:59], s67 offen sc1
    s_add_u32 s8, s66, 0
    buffer_load_dwordx4 v[96:99], v9, s[56:59], s8 offen sc1
    s_add_u32 s8, s66, 4096
    buffer_load_dwordx4 v[100:103], v9, s[56:59], s8 offen sc1
    s_add_u32 s8, s66, 8192
    buffer_load_dwordx4 v[104:107], v9, s[56:59], s8 offen sc1
    s_add_u32 s8, s66, 12288
    buffer_load_dwordx4 v[108:111], v9, s[56:59], s8 offen sc1
    s_add_u32 s8, s66, 16384
    buffer_load_dwordx4 v[120:123], v9, s[56:59], s8 offen sc1
    s_add_u32 s8, s66, 20480
    buffer_load_dwordx4 v[30:33], v9, s[56:59], s8 offen sc1
    s_add_u32 s8, s66, 24576
    buffer_load_dwordx4 v[34:37], v9, s[56:59], s8 offen sc1
    s_add_u32 s8, s66, 28672
    buffer_load_dwordx4 a[0:3], v9, s[56:59], s8 offen sc1
    s_add_u32 s8, s66, 32768
    buffer_load_dwordx4 a[4:7], v9, s[56:59], s8 offen sc1
    s_add_u32 s8, s66, 36864
    buffer_load_dwordx4 a[8:11], v9, s[56:59], s8 offen sc1
    s_add_u32 s8, s66, 40960
    buffer_load_dwordx4 a[12:15], v9, s[56:59], s8 offen sc1
    s_add_u32 s8, s66, 45056
    buffer_load_dwordx4 a[16:19], v9, s[56:59], s8 offen sc1
    s_add_u32 s8, s66, 49152
    buffer_load_dwordx4 a[20:23], v9, s[56:59], s8 offen sc1
    s_add_u32 s8, s66, 53248
    buffer_load_dwordx4 a[24:27], v9, s[56:59], s8 offen sc1
    s_add_u32 s8, s66, 57344
    buffer_load_dwordx4 a[28:31], v9, s[56:59], s8 offen sc1
    s_add_u32 s8, s66, 61440
    buffer_load_dwordx4 a[32:35], v9, s[56:59], s8 offen sc1
    s_mov_b32 s9, 0
    s_mov_b32 s4, 0x3f80
    s_mov_b32 s5, 0x3f800000
    s_waitcnt vmcnt(16)
    v_xor_b32 v42, v21, v18
    s_waitcnt vmcnt(15)
    v_xor_b32 v43, v99, v18
    v_or_b32 v42, v42, v43
    v_dot2_f32_bf16 v48, v96, s4, 0
    v_dot2_f32_bf16 v49, v96, s5, 0
    v_dot2_f32_bf16 v50, v97, s4, 0
    v_dot2_f32_bf16 v51, v97, s5, 0
    v_dot2_f32_bf16 v52, v98, s4, 0
    v_dot2_f32_bf16 v53, v98, s5, 0
    s_waitcnt vmcnt(14)
    v_xor_b32 v43, v103, v18
    v_or_b32 v42, v42, v43
    v_dot2_f32_bf16 v48, v100, s4, v48
    v_dot2_f32_bf16 v49, v100, s5, v49
    v_dot2_f32_bf16 v50, v101, s4, v50
    v_dot2_f32_bf16 v51, v101, s5, v51
    v_dot2_f32_bf16 v52, v102, s4, v52
    v_dot2_f32_bf16 v53, v102, s5, v53
    s_waitcnt vmcnt(13)
    v_xor_b32 v43, v107, v18
    v_or_b32 v42, v42, v43
    v_dot2_f32_bf16 v48, v104, s4, v48
    v_dot2_f32_bf16 v49, v104, s5, v49
    v_dot2_f32_bf16 v50, v105, s4, v50
    v_dot2_f32_bf16 v51, v105, s5, v51
    v_dot2_f32_bf16 v52, v106, s4, v52
    v_dot2_f32_bf16 v53, v106, s5, v53
    s_waitcnt vmcnt(12)
    v_xor_b32 v43, v111, v18
    v_or_b32 v42, v42, v43
    v_dot2_f32_bf16 v48, v108, s4, v48
    v_dot2_f32_bf16 v49, v108, s5, v49
    v_dot2_f32_bf16 v50, v109, s4, v50
    v_dot2_f32_bf16 v51, v109, s5, v51
    v_dot2_f32_bf16 v52, v110, s4, v52
    v_dot2_f32_bf16 v53, v110, s5, v53
    s_waitcnt vmcnt(11)
    v_xor_b32 v43, v123, v18
    v_or_b32 v42, v42, v43
    v_dot2_f32_bf16 v48, v120, s4, v48
    v_dot2_f32_bf16 v49, v120, s5, v49
    v_dot2_f32_bf16 v50, v121, s4, v50
    v_dot2_f32_bf16 v51, v121, s5, v51
    v_dot2_f32_bf16 v52, v122, s4, v52
    v_dot2_f32_bf16 v53, v122, s5, v53
    s_waitcnt vmcnt(10)
    v_xor_b32 v43, v33, v18
    v_or_b32 v42, v42, v43
    v_dot2_f32_bf16 v48, v30, s4, v48
    v_dot2_f32_bf16 v49, v30, s5, v49
    v_dot2_f32_bf16 v50, v31, s4, v50
    v_dot2_f32_bf16 v51, v31, s5, v51
    v_dot2_f32_bf16 v52, v32, s4, v52
    v_dot2_f32_bf16 v53, v32, s5, v53
    s_waitcnt vmcnt(9)
    v_xor_b32 v43, v37, v18
    v_or_b32 v42, v42, v43
    v_dot2_f32_bf16 v48, v34, s4, v48
    v_dot2_f32_bf16 v49, v34, s5, v49
    v_dot2_f32_bf16 v50, v35, s4, v50
    v_dot2_f32_bf16 v51, v35, s5, v51
    v_dot2_f32_bf16 v52, v36, s4, v52
    v_dot2_f32_bf16 v53, v36, s5, v53
    s_waitcnt vmcnt(8)
    v_accvgpr_read_b32 v83, a3
    v_accvgpr_read_b32 v80, a0
    v_accvgpr_read_b32 v81, a1
    v_accvgpr_read_b32 v82, a2
    v_xor_b32 v43, v83, v18
    v_or_b32 v42, v42, v43
    v_dot2_f32_bf16 v48, v80, s4, v48
    v_dot2_f32_bf16 v49, v80, s5, v49
    v_dot2_f32_bf16 v50, v81, s4, v50
    v_dot2_f32_bf16 v51, v81, s5, v51
    v_dot2_f32_bf16 v52, v82, s4, v52
    v_dot2_f32_bf16 v53, v82, s5, v53
    s_waitcnt vmcnt(7)
    v_accvgpr_read_b32 v87, a7
    v_accvgpr_read_b32 v84, a4
    v_accvgpr_read_b32 v85, a5
    v_accvgpr_read_b32 v86, a6
    v_xor_b32 v43, v87, v18
    v_or_b32 v42, v42, v43
    v_dot2_f32_bf16 v48, v84, s4, v48
    v_dot2_f32_bf16 v49, v84, s5, v49
    v_dot2_f32_bf16 v50, v85, s4, v50
    v_dot2_f32_bf16 v51, v85, s5, v51
    v_dot2_f32_bf16 v52, v86, s4, v52
    v_dot2_f32_bf16 v53, v86, s5, v53
    s_waitcnt vmcnt(6)
    v_accvgpr_read_b32 v91, a11
    v_accvgpr_read_b32 v88, a8
    v_accvgpr_read_b32 v89, a9
    v_accvgpr_read_b32 v90, a10
    v_xor_b32 v43, v91, v18
    v_or_b32 v42, v42, v43
    v_dot2_f32_bf16 v48, v88, s4, v48
    v_dot2_f32_bf16 v49, v88, s5, v49
    v_dot2_f32_bf16 v50, v89, s4, v50
    v_dot2_f32_bf16 v51, v89, s5, v51
    v_dot2_f32_bf16 v52, v90, s4, v52
    v_dot2_f32_bf16 v53, v90, s5, v53
    s_waitcnt vmcnt(5)
    v_accvgpr_read_b32 v95, a15
    v_accvgpr_read_b32 v92, a12
    v_accvgpr_read_b32 v93, a13
    v_accvgpr_read_b32 v94, a14
    v_xor_b32 v43, v95, v18
    v_or_b32 v42, v42, v43
    v_dot2_f32_bf16 v48, v92, s4, v48
    v_dot2_f32_bf16 v49, v92, s5, v49
    v_dot2_f32_bf16 v50, v93, s4, v50
    v_dot2_f32_bf16 v51, v93, s5, v51
    v_dot2_f32_bf16 v52, v94, s4, v52
    v_dot2_f32_bf16 v53, v94, s5, v53
    s_waitcnt vmcnt(4)
    v_accvgpr_read_b32 v83, a19
    v_accvgpr_read_b32 v80, a16
    v_accvgpr_read_b32 v81, a17
    v_accvgpr_read_b32 v82, a18
    v_xor_b32 v43, v83, v18
    v_or_b32 v42, v42, v43
    v_dot2_f32_bf16 v48, v80, s4, v48
    v_dot2_f32_bf16 v49, v80, s5, v49
    v_dot2_f32_bf16 v50, v81, s4, v50
    v_dot2_f32_bf16 v51, v81, s5, v51
    v_dot2_f32_bf16 v52, v82, s4, v52
    v_dot2_f32_bf16 v53, v82, s5, v53
    s_waitcnt vmcnt(3)
    v_accvgpr_read_b32 v87, a23
    v_accvgpr_read_b32 v84, a20
    v_accvgpr_read_b32 v85, a21
    v_accvgpr_read_b32 v86, a22
    v_xor_b32 v43, v87, v18
    v_or_b32 v42, v42, v43
    v_dot2_f32_bf16 v48, v84, s4, v48
    v_dot2_f32_bf16 v49, v84, s5, v49
    v_dot2_f32_bf16 v50, v85, s4, v50
    v_dot2_f32_bf16 v51, v85, s5, v51
    v_dot2_f32_bf16 v52, v86, s4, v52
    v_dot2_f32_bf16 v53, v86, s5, v53
    s_waitcnt vmcnt(2)
    v_accvgpr_read_b32 v91, a27
    v_accvgpr_read_b32 v88, a24
    v_accvgpr_read_b32 v89, a25
    v_accvgpr_read_b32 v90, a26
    v_xor_b32 v43, v91, v18
    v_or_b32 v42, v42, v43
    v_dot2_f32_bf16 v48, v88, s4, v48
    v_dot2_f32_bf16 v49, v88, s5, v49
    v_dot2_f32_bf16 v50, v89, s4, v50
    v_dot2_f32_bf16 v51, v89, s5, v51
    v_dot2_f32_bf16 v52, v90, s4, v52
    v_dot2_f32_bf16 v53, v90, s5, v53
    s_waitcnt vmcnt(1)
    v_accvgpr_read_b32 v95, a31
    v_accvgpr_read_b32 v92, a28
    v_accvgpr_read_b32 v93, a29
    v_accvgpr_read_b32 v94, a30
    v_xor_b32 v43, v95, v18
    v_or_b32 v42, v42, v43
    v_dot2_f32_bf16 v48, v92, s4, v48
    v_dot2_f32_bf16 v49, v92, s5, v49
    v_dot2_f32_bf16 v50, v93, s4, v50
    v_dot2_f32_bf16 v51, v93, s5, v51
    v_dot2_f32_bf16 v52, v94, s4, v52
    v_dot2_f32_bf16 v53, v94, s5, v53
    s_waitcnt vmcnt(0)
    v_accvgpr_read_b32 v83, a35
    v_accvgpr_read_b32 v80, a32
    v_accvgpr_read_b32 v81, a33
    v_accvgpr_read_b32 v82, a34
    v_xor_b32 v43, v83, v18
    v_or_b32 v42, v42, v43
    v_dot2_f32_bf16 v48, v80, s4, v48
    v_dot2_f32_bf16 v49, v80, s5, v49
    v_dot2_f32_bf16 v50, v81, s4, v50
    v_dot2_f32_bf16 v51, v81, s5, v51
    v_dot2_f32_bf16 v52, v82, s4, v52
    v_dot2_f32_bf16 v53, v82, s5, v53
    v_cmp_ne_u32 vcc, 0, v42
    s_cmp_eq_u64 vcc, 0
    s_cbranch_scc1 L_kv_ok
L_kv_again:
    s_sleep 2
    buffer_load_dwordx2 v[20:21], v19, s[56:59], s67 offen sc1
    s_add_u32 s8, s66, 0
    buffer_load_dwordx4 v[96:99], v9, s[56:59], s8 offen sc1
    s_add_u32 s8, s66, 4096
    buffer_load_dwordx4 v[100:103], v9, s[56:59], s8 offen sc1
    s_add_u32 s8, s66, 8192
    buffer_load_dwordx4 v[104:107], v9, s[56:59], s8 offen sc1
    s_add_u32 s8, s66, 12288
    buffer_load_dwordx4 v[108:111], v9, s[56:59], s8 offen sc1
    s_add_u32 s8, s66, 16384
    buffer_load_dwordx4 v[120:123], v9, s[56:59], s8 offen sc1
    s_add_u32 s8, s66, 20480
    buffer_load_dwordx4 v[30:33], v9, s[56:59], s8 offen sc1
    s_add_u32 s8, s66, 24576
    buffer_load_dwordx4 v[34:37], v9, s[56:59], s8 offen sc1
    s_add_u32 s8, s66, 28672
    buffer_load_dwordx4 a[0:3], v9, s[56:59], s8 offen sc1
    s_add_u32 s8, s66, 32768
    buffer_load_dwordx4 a[4:7], v9, s[56:59], s8 offen sc1
    s_add_u32 s8, s66, 36864
    buffer_load_dwordx4 a[8:11], v9, s[56:59], s8 offen sc1
    s_add_u32 s8, s66, 40960
    buffer_load_dwordx4 a[12:15], v9, s[56:59], s8 offen sc1
    s_add_u32 s8, s66, 45056
    buffer_load_dwordx4 a[16:19], v9, s[56:59], s8 offen sc1
    s_add_u32 s8, s66, 49152
    buffer_load_dwordx4 a[20:23], v9, s[56:59], s8 offen sc1
    s_add_u32 s8, s66, 53248
    buffer_load_dwordx4 a[24:27], v9, s[56:59], s8 offen sc1
    s_add_u32 s8, s66, 57344
    buffer_load_dwordx4 a[28:31], v9, s[56:59], s8 offen sc1
    s_add_u32 s8, s66, 61440
    buffer_load_dwordx4 a[32:35], v9, s[56:59], s8 offen sc1
    s_add_u32 s9, s9, 1
    s_mov_b32 s4, 0x3f80
    s_mov_b32 s5, 0x3f800000
    s_waitcnt vmcnt(16)
    v_xor_b32 v42, v21, v18
    s_waitcnt vmcnt(15)
    v_xor_b32 v43, v99, v18
    v_or_b32 v42, v42, v43
    v_dot2_f32_bf16 v48, v96, s4, 0
    v_dot2_f32_bf16 v49, v96, s5, 0
    v_dot2_f32_bf16 v50, v97, s4, 0
    v_dot2_f32_bf16 v51, v97, s5, 0
    v_dot2_f32_bf16 v52, v98, s4, 0
    v_dot2_f32_bf16 v53, v98, s5, 0
    s_waitcnt vmcnt(14)
    v_xor_b32 v43, v103, v18
    v_or_b32 v42, v42, v43
    v_dot2_f32_bf16 v48, v100, s4, v48
    v_dot2_f32_bf16 v49, v100, s5, v49
    v_dot2_f32_bf16 v50, v101, s4, v50
    v_dot2_f32_bf16 v51, v101, s5, v51
    v_dot2_f32_bf16 v52, v102, s4, v52
    v_dot2_f32_bf16 v53, v102, s5, v53
    s_waitcnt vmcnt(13)
    v_xor_b32 v43, v107, v18
    v_or_b32 v42, v42, v43
    v_dot2_f32_bf16 v48, v104, s4, v48
    v_dot2_f32_bf16 v49, v104, s5, v49
    v_dot2_f32_bf16 v50, v105, s4, v50
    v_dot2_f32_bf16 v51, v105, s5, v51
    v_dot2_f32_bf16 v52, v106, s4, v52
    v_dot2_f32_bf16 v53, v106, s5, v53
    s_waitcnt vmcnt(12)
    v_xor_b32 v43, v111, v18
    v_or_b32 v42, v42, v43
    v_dot2_f32_bf16 v48, v108, s4, v48
    v_dot2_f32_bf16 v49, v108, s5, v49
    v_dot2_f32_bf16 v50, v109, s4, v50
    v_dot2_f32_bf16 v51, v109, s5, v51
    v_dot2_f32_bf16 v52, v110, s4, v52
    v_dot2_f32_bf16 v53, v110, s5, v53
    s_waitcnt vmcnt(11)
    v_xor_b32 v43, v123, v18
    v_or_b32 v42, v42, v43
    v_dot2_f32_bf16 v48, v120, s4, v48
    v_dot2_f32_bf16 v49, v120, s5, v49
    v_dot2_f32_bf16 v50, v121, s4, v50
    v_dot2_f32_bf16 v51, v121, s5, v51
    v_dot2_f32_bf16 v52, v122, s4, v52
    v_dot2_f32_bf16 v53, v122, s5, v53
    s_waitcnt vmcnt(10)
    v_xor_b32 v43, v33, v18
    v_or_b32 v42, v42, v43
    v_dot2_f32_bf16 v48, v30, s4, v48
    v_dot2_f32_bf16 v49, v30, s5, v49
    v_dot2_f32_bf16 v50, v31, s4, v50
    v_dot2_f32_bf16 v51, v31, s5, v51
    v_dot2_f32_bf16 v52, v32, s4, v52
    v_dot2_f32_bf16 v53, v32, s5, v53
    s_waitcnt vmcnt(9)
    v_xor_b32 v43, v37, v18
    v_or_b32 v42, v42, v43
    v_dot2_f32_bf16 v48, v34, s4, v48
    v_dot2_f32_bf16 v49, v34, s5, v49
    v_dot2_f32_bf16 v50, v35, s4, v50
    v_dot2_f32_bf16 v51, v35, s5, v51
    v_dot2_f32_bf16 v52, v36, s4, v52
    v_dot2_f32_bf16 v53, v36, s5, v53
    s_waitcnt vmcnt(8)
    v_accvgpr_read_b32 v83, a3
    v_accvgpr_read_b32 v80, a0
    v_accvgpr_read_b32 v81, a1
    v_accvgpr_read_b32 v82, a2
    v_xor_b32 v43, v83, v18
    v_or_b32 v42, v42, v43
    v_dot2_f32_bf16 v48, v80, s4, v48
    v_dot2_f32_bf16 v49, v80, s5, v49
    v_dot2_f32_bf16 v50, v81, s4, v50
    v_dot2_f32_bf16 v51, v81, s5, v51
    v_dot2_f32_bf16 v52, v82, s4, v52
    v_dot2_f32_bf16 v53, v82, s5, v53
    s_waitcnt vmcnt(7)
    v_accvgpr_read_b32 v87, a7
    v_accvgpr_read_b32 v84, a4
    v_accvgpr_read_b32 v85, a5
    v_accvgpr_read_b32 v86, a6
    v_xor_b32 v43, v87, v18
    v_or_b32 v42, v42, v43
    v_dot2_f32_bf16 v48, v84, s4, v48
    v_dot2_f32_bf16 v49, v84, s5, v49
    v_dot2_f32_bf16 v50, v85, s4, v50
    v_dot2_f32_bf16 v51, v85, s5, v51
    v_dot2_f32_bf16 v52, v86, s4, v52
    v_dot2_f32_bf16 v53, v86, s5, v53
    s_waitcnt vmcnt(6)
    v_accvgpr_read_b32 v91, a11
    v_accvgpr_read_b32 v88, a8
    v_accvgpr_read_b32 v89, a9
    v_accvgpr_read_b32 v90, a10
    v_xor_b32 v43, v91, v18
    v_or_b32 v42, v42, v43
    v_dot2_f32_bf16 v48, v88, s4, v48
    v_dot2_f32_bf16 v49, v88, s5, v49
    v_dot2_f32_bf16 v50, v89, s4, v50
    v_dot2_f32_bf16 v51, v89, s5, v51
    v_dot2_f32_bf16 v52, v90, s4, v52
    v_dot2_f32_bf16 v53, v90, s5, v53
    s_waitcnt vmcnt(5)
    v_accvgpr_read_b32 v95, a15
    v_accvgpr_read_b32 v92, a12
    v_accvgpr_read_b32 v93, a13
    v_accvgpr_read_b32 v94, a14
    v_xor_b32 v43, v95, v18
    v_or_b32 v42, v42, v43
    v_dot2_f32_bf16 v48, v92, s4, v48
    v_dot2_f32_bf16 v49, v92, s5, v49
    v_dot2_f32_bf16 v50, v93, s4, v50
    v_dot2_f32_bf16 v51, v93, s5, v51
    v_dot2_f32_bf16 v52, v94, s4, v52
    v_dot2_f32_bf16 v53, v94, s5, v53
    s_waitcnt vmcnt(4)
    v_accvgpr_read_b32 v83, a19
    v_accvgpr_read_b32 v80, a16
    v_accvgpr_read_b32 v81, a17
    v_accvgpr_read_b32 v82, a18
    v_xor_b32 v43, v83, v18
    v_or_b32 v42, v42, v43
    v_dot2_f32_bf16 v48, v80, s4, v48
    v_dot2_f32_bf16 v49, v80, s5, v49
    v_dot2_f32_bf16 v50, v81, s4, v50
    v_dot2_f32_bf16 v51, v81, s5, v51
    v_dot2_f32_bf16 v52, v82, s4, v52
    v_dot2_f32_bf16 v53, v82, s5, v53
    s_waitcnt vmcnt(3)
    v_accvgpr_read_b32 v87, a23
    v_accvgpr_read_b32 v84, a20
    v_accvgpr_read_b32 v85, a21
    v_accvgpr_read_b32 v86, a22
    v_xor_b32 v43, v87, v18
    v_or_b32 v42, v42, v43
    v_dot2_f32_bf16 v48, v84, s4, v48
    v_dot2_f32_bf16 v49, v84, s5, v49
    v_dot2_f32_bf16 v50, v85, s4, v50
    v_dot2_f32_bf16 v51, v85, s5, v51
    v_dot2_f32_bf16 v52, v86, s4, v52
    v_dot2_f32_bf16 v53, v86, s5, v53
    s_waitcnt vmcnt(2)
    v_accvgpr_read_b32 v91, a27
    v_accvgpr_read_b32 v88, a24
    v_accvgpr_read_b32 v89, a25
    v_accvgpr_read_b32 v90, a26
    v_xor_b32 v43, v91, v18
    v_or_b32 v42, v42, v43
    v_dot2_f32_bf16 v48, v88, s4, v48
    v_dot2_f32_bf16 v49, v88, s5, v49
    v_dot2_f32_bf16 v50, v89, s4, v50
    v_dot2_f32_bf16 v51, v89, s5, v51
    v_dot2_f32_bf16 v52, v90, s4, v52
    v_dot2_f32_bf16 v53, v90, s5, v53
    s_waitcnt vmcnt(1)
    v_accvgpr_read_b32 v95, a31
    v_accvgpr_read_b32 v92, a28
    v_accvgpr_read_b32 v93, a29
    v_accvgpr_read_b32 v94, a30
    v_xor_b32 v43, v95, v18
    v_or_b32 v42, v42, v43
    v_dot2_f32_bf16 v48, v92, s4, v48
    v_dot2_f32_bf16 v49, v92, s5, v49
    v_dot2_f32_bf16 v50, v93, s4, v50
    v_dot2_f32_bf16 v51, v93, s5, v51
    v_dot2_f32_bf16 v52, v94, s4, v52
    v_dot2_f32_bf16 v53, v94, s5, v53
    s_waitcnt vmcnt(0)
    v_accvgpr_read_b32 v83, a35
    v_accvgpr_read_b32 v80, a32
    v_accvgpr_read_b32 v81, a33
    v_accvgpr_read_b32 v82, a34
    v_xor_b32 v43, v83, v18
    v_or_b32 v42, v42, v43
    v_dot2_f32_bf16 v48, v80, s4, v48
    v_dot2_f32_bf16 v49, v80, s5, v49
    v_dot2_f32_bf16 v50, v81, s4, v50
    v_dot2_f32_bf16 v51, v81, s5, v51
    v_dot2_f32_bf16 v52, v82, s4, v52
    v_dot2_f32_bf16 v53, v82, s5, v53
    v_cmp_ne_u32 vcc, 0, v42
    s_cmp_eq_u64 vcc, 0
    s_cbranch_scc1 L_kv_ok
    s_cmp_lt_u32 s9, 50000
    s_cbranch_scc1 L_kv_again
L_kv_ok:
    v_cvt_pk_bf16_f32 v38, v48, v49
    v_cvt_pk_bf16_f32 v39, v50, v51
    v_cvt_pk_bf16_f32 v40, v52, v53
    ds_write_b32 v3, v38 offset:0
    ds_write_b32 v3, v39 offset:4
    ds_write_b32 v3, v40 offset:8
    v_cmp_ne_u32 vcc, s68, v20
    s_cmp_eq_u64 vcc, 0
    s_cselect_b32 s74, 1, 0
    s_waitcnt lgkmcnt(0)
    s_barrier
    ds_read_b64 v[80:81], v4 offset:0
    ds_read_b64 v[82:83], v4 offset:16
    ds_read_b64 v[84:85], v4 offset:32
    ds_read_b64 v[86:87], v4 offset:48
    ds_read_b64 v[88:89], v126 offset:0
    ds_read_b64 v[90:91], v126 offset:16
    ds_read_b64 v[92:93], v126 offset:32
    ds_read_b64 v[94:95], v126 offset:48
    ds_read_b64_tr_b16 a[0:1], v12 offset:16384
    ds_read_b64_tr_b16 a[2:3], v12 offset:16896
    ds_read_b64_tr_b16 a[4:5], v12 offset:18432
    ds_read_b64_tr_b16 a[6:7], v12 offset:18944
    ds_read_b64_tr_b16 a[8:9], v12 offset:20480
    ds_read_b64_tr_b16 a[10:11], v12 offset:20992
    ds_read_b64_tr_b16 a[12:13], v12 offset:22528
    ds_read_b64_tr_b16 a[14:15], v12 offset:23040
    ds_read_b64_tr_b16 a[16:17], v12 offset:24576
    ds_read_b64_tr_b16 a[18:19], v12 offset:25088
    ds_read_b64_tr_b16 a[20:21], v12 offset:26624
    ds_read_b64_tr_b16 a[22:23], v12 offset:27136
    ds_read_b64_tr_b16 a[24:25], v12 offset:28672
    ds_read_b64_tr_b16 a[26:27], v12 offset:29184
    ds_read_b64_tr_b16 a[28:29], v12 offset:30720
    ds_read_b64_tr_b16 a[30:31], v12 offset:31232
    s_waitcnt lgkmcnt(15)
    v_mfma_f32_32x32x16_bf16 v[48:63], v[80:83], v[64:67], 0
    v_mfma_f32_32x32x16_bf16 v[48:63], v[84:87], v[68:71], v[48:63]
    v_mfma_f32_32x32x16_bf16 v[96:111], v[88:91], v[72:75], 0
    v_mfma_f32_32x32x16_bf16 v[96:111], v[92:95], v[76:79], v[96:111]
    s_mov_b32 s4, 0x358637bd
    s_nop 8
    v_add_f32 v38, s4, v56
    s_nop 0
    v_add_f32 v39, s4, v96
    v_rcp_f32 v38, v38
    v_rcp_f32 v39, v39
    v_mul_f32 v48, v48, v38
    v_mul_f32 v56, v104, v39
    v_mul_f32 v49, v49, v38
    v_mul_f32 v57, v105, v39
    v_mul_f32 v50, v50, v38
    v_mul_f32 v58, v106, v39
    v_mul_f32 v51, v51, v38
    v_mul_f32 v59, v107, v39
    v_mul_f32 v52, v52, v38
    v_mul_f32 v60, v108, v39
    v_mul_f32 v53, v53, v38
    v_mul_f32 v61, v109, v39
    v_mul_f32 v54, v54, v38
    v_mul_f32 v62, v110, v39
    v_mul_f32 v55, v55, v38
    v_mul_f32 v63, v111, v39
    v_cvt_pk_bf16_f32 v112, v48, v49
    v_cvt_pk_bf16_f32 v113, v50, v51
    v_cvt_pk_bf16_f32 v114, v52, v53
    v_cvt_pk_bf16_f32 v115, v54, v55
    v_cvt_pk_bf16_f32 v116, v56, v57
    v_cvt_pk_bf16_f32 v117, v58, v59
    v_cvt_pk_bf16_f32 v118, v60, v61
    v_cvt_pk_bf16_f32 v119, v62, v63
    v_permlane32_swap_b32 v112, v114
    v_permlane32_swap_b32 v113, v115
    v_permlane32_swap_b32 v116, v118
    v_permlane32_swap_b32 v117, v119
    s_cmp_eq_u32 s74, 1
    s_cbranch_scc0 L_o_remote
    buffer_store_dwordx4 v[112:115], v2, s[56:59], s71 offen offset:0
    buffer_store_dwordx4 v[116:119], v2, s[56:59], s71 offen offset:32
    ds_read_b64_tr_b16 a[32:33], v12 offset:32768
    ds_read_b64_tr_b16 a[34:35], v12 offset:33280
    ds_read_b64_tr_b16 a[36:37], v12 offset:34816
    ds_read_b64_tr_b16 a[38:39], v12 offset:35328
    ds_read_b64_tr_b16 a[40:41], v12 offset:36864
    ds_read_b64_tr_b16 a[42:43], v12 offset:37376
    ds_read_b64_tr_b16 a[44:45], v12 offset:38912
    ds_read_b64_tr_b16 a[46:47], v12 offset:39424
    ds_read_b64_tr_b16 a[48:49], v12 offset:40960
    ds_read_b64_tr_b16 a[50:51], v12 offset:41472
    ds_read_b64_tr_b16 a[52:53], v12 offset:43008
    ds_read_b64_tr_b16 a[54:55], v12 offset:43520
    ds_read_b64_tr_b16 a[56:57], v12 offset:45056
    ds_read_b64_tr_b16 a[58:59], v12 offset:45568
    ds_read_b64_tr_b16 a[60:61], v12 offset:47104
    ds_read_b64_tr_b16 a[62:63], v12 offset:47616
    s_waitcnt vmcnt(0)
    v_mov_b32 v38, 0
    s_mov_b64 exec, 1
    buffer_store_dword v18, v38, s[56:59], s69 offen
    s_mov_b64 exec, -1
    s_branch L_o_pub
L_o_remote:
    buffer_store_dwordx4 v[112:115], v2, s[56:59], s71 offen offset:0 sc1
    buffer_store_dwordx4 v[116:119], v2, s[56:59], s71 offen offset:32 sc1
    ds_read_b64_tr_b16 a[32:33], v12 offset:32768
    ds_read_b64_tr_b16 a[34:35], v12 offset:33280
    ds_read_b64_tr_b16 a[36:37], v12 offset:34816
    ds_read_b64_tr_b16 a[38:39], v12 offset:35328
    ds_read_b64_tr_b16 a[40:41], v12 offset:36864
    ds_read_b64_tr_b16 a[42:43], v12 offset:37376
    ds_read_b64_tr_b16 a[44:45], v12 offset:38912
    ds_read_b64_tr_b16 a[46:47], v12 offset:39424
    ds_read_b64_tr_b16 a[48:49], v12 offset:40960
    ds_read_b64_tr_b16 a[50:51], v12 offset:41472
    ds_read_b64_tr_b16 a[52:53], v12 offset:43008
    ds_read_b64_tr_b16 a[54:55], v12 offset:43520
    ds_read_b64_tr_b16 a[56:57], v12 offset:45056
    ds_read_b64_tr_b16 a[58:59], v12 offset:45568
    ds_read_b64_tr_b16 a[60:61], v12 offset:47104
    ds_read_b64_tr_b16 a[62:63], v12 offset:47616
    s_waitcnt vmcnt(0)
    v_mov_b32 v38, 0
    s_mov_b64 exec, 1
    buffer_store_dword v18, v38, s[56:59], s69 offen sc1
    s_mov_b64 exec, -1
L_o_pub:
    v_and_b32 v5, 31, v1
    v_lshlrev_b32 v5, 2, v5
    s_barrier
    ds_read_b64_tr_b16 a[64:65], v12 offset:49152
    ds_read_b64_tr_b16 a[66:67], v12 offset:49664
    ds_read_b64_tr_b16 a[68:69], v12 offset:51200
    ds_read_b64_tr_b16 a[70:71], v12 offset:51712
    ds_read_b64_tr_b16 a[72:73], v12 offset:53248
    ds_read_b64_tr_b16 a[74:75], v12 offset:53760
    ds_read_b64_tr_b16 a[76:77], v12 offset:55296
    ds_read_b64_tr_b16 a[78:79], v12 offset:55808
    ds_read_b64_tr_b16 a[80:81], v12 offset:57344
    ds_read_b64_tr_b16 a[82:83], v12 offset:57856
    ds_read_b64_tr_b16 a[84:85], v12 offset:59392
    ds_read_b64_tr_b16 a[86:87], v12 offset:59904
    ds_read_b64_tr_b16 a[88:89], v12 offset:61440
    ds_read_b64_tr_b16 a[90:91], v12 offset:61952
    ds_read_b64_tr_b16 a[92:93], v12 offset:63488
    ds_read_b64_tr_b16 a[94:95], v12 offset:64000
    ds_read_b64_tr_b16 a[96:97], v12 offset:0
    ds_read_b64_tr_b16 a[98:99], v12 offset:512
    ds_read_b64_tr_b16 a[100:101], v12 offset:2048
    ds_read_b64_tr_b16 a[102:103], v12 offset:2560
    ds_read_b64_tr_b16 a[104:105], v12 offset:4096
    ds_read_b64_tr_b16 a[106:107], v12 offset:4608
    ds_read_b64_tr_b16 a[108:109], v12 offset:6144
    ds_read_b64_tr_b16 a[110:111], v12 offset:6656
    ds_read_b64_tr_b16 a[112:113], v12 offset:8192
    ds_read_b64_tr_b16 a[114:115], v12 offset:8704
    ds_read_b64_tr_b16 a[116:117], v12 offset:10240
    ds_read_b64_tr_b16 a[118:119], v12 offset:10752
    ds_read_b64_tr_b16 a[120:121], v12 offset:12288
    ds_read_b64_tr_b16 a[122:123], v12 offset:12800
    ds_read_b64_tr_b16 a[124:125], v12 offset:14336
    ds_read_b64_tr_b16 a[126:127], v12 offset:14848
    s_waitcnt lgkmcnt(0)
    s_barrier
    s_mov_b32 s9, 0
L_poll_o:
    buffer_load_dword v38, v5, s[56:59], s70 offen sc1
    s_add_u32 s9, s9, 1
    s_waitcnt vmcnt(0)
    v_cmp_eq_u32 vcc, v38, v18
    s_cmp_gt_u32 s9, 200000
    s_cbranch_scc1 L_poll_o_x
    s_cmp_eq_u64 vcc, exec
    s_cbranch_scc0 L_poll_o
L_poll_o_x:
    s_add_u32 s8, s75, 0
    s_and_b32 s8, s8, 7
    s_lshl_b32 s8, s8, 7
    s_add_u32 s8, s8, s98
    s_add_u32 m0, s60, 0
    s_nop 0
    buffer_load_dwordx4 v124, s[56:59], s8 offen sc1 lds
    s_add_u32 m0, s60, 4096
    s_nop 0
    buffer_load_dwordx4 v125, s[56:59], s8 offen sc1 lds
    s_add_u32 s8, s75, 1
    s_and_b32 s8, s8, 7
    s_lshl_b32 s8, s8, 7
    s_add_u32 s8, s8, s98
    s_add_u32 m0, s60, 8192
    s_nop 0
    buffer_load_dwordx4 v124, s[56:59], s8 offen sc1 lds
    s_add_u32 m0, s60, 12288
    s_nop 0
    buffer_load_dwordx4 v125, s[56:59], s8 offen sc1 lds
    s_add_u32 s8, s75, 2
    s_and_b32 s8, s8, 7
    s_lshl_b32 s8, s8, 7
    s_add_u32 s8, s8, s98
    s_add_u32 m0, s60, 16384
    s_nop 0
    buffer_load_dwordx4 v124, s[56:59], s8 offen sc1 lds
    s_add_u32 m0, s60, 20480
    s_nop 0
    buffer_load_dwordx4 v125, s[56:59], s8 offen sc1 lds
    s_add_u32 s8, s75, 3
    s_and_b32 s8, s8, 7
    s_lshl_b32 s8, s8, 7
    s_add_u32 s8, s8, s98
    s_add_u32 m0, s60, 24576
    s_nop 0
    buffer_load_dwordx4 v124, s[56:59], s8 offen sc1 lds
    s_add_u32 m0, s60, 28672
    s_nop 0
    buffer_load_dwordx4 v125, s[56:59], s8 offen sc1 lds
    s_add_u32 s8, s75, 4
    s_and_b32 s8, s8, 7
    s_lshl_b32 s8, s8, 7
    s_add_u32 s8, s8, s98
    s_add_u32 m0, s60, 32768
    s_nop 0
    buffer_load_dwordx4 v124, s[56:59], s8 offen sc1 lds
    s_add_u32 m0, s60, 36864
    s_nop 0
    buffer_load_dwordx4 v125, s[56:59], s8 offen sc1 lds
    s_add_u32 s8, s75, 5
    s_and_b32 s8, s8, 7
    s_lshl_b32 s8, s8, 7
    s_add_u32 s8, s8, s98
    s_add_u32 m0, s60, 40960
    s_nop 0
    buffer_load_dwordx4 v124, s[56:59], s8 offen sc1 lds
    s_add_u32 m0, s60, 45056
    s_nop 0
    buffer_load_dwordx4 v125, s[56:59], s8 offen sc1 lds
    s_add_u32 s8, s75, 6
    s_and_b32 s8, s8, 7
    s_lshl_b32 s8, s8, 7
    s_add_u32 s8, s8, s98
    s_add_u32 m0, s60, 49152
    s_nop 0
    buffer_load_dwordx4 v124, s[56:59], s8 offen sc1 lds
    s_add_u32 m0, s60, 53248
    s_nop 0
    buffer_load_dwordx4 v125, s[56:59], s8 offen sc1 lds
    s_add_u32 s8, s75, 7
    s_and_b32 s8, s8, 7
    s_lshl_b32 s8, s8, 7
    s_add_u32 s8, s8, s98
    s_add_u32 m0, s60, 57344
    s_nop 0
    buffer_load_dwordx4 v124, s[56:59], s8 offen sc1 lds
    s_add_u32 m0, s60, 61440
    s_nop 0
    buffer_load_dwordx4 v125, s[56:59], s8 offen sc1 lds
    s_waitcnt vmcnt(12)
    s_barrier
    ds_read_b128 v[80:83], v13 offset:0
    ds_read_b128 v[84:87], v14 offset:0
    ds_read_b128 v[88:91], v15 offset:0
    ds_read_b128 v[92:95], v16 offset:0
    ds_read_b128 v[96:99], v13 offset:8192
    ds_read_b128 v[100:103], v14 offset:8192
    ds_read_b128 v[104:107], v15 offset:8192
    ds_read_b128 v[108:111], v16 offset:8192
    s_waitcnt lgkmcnt(7)
    v_mfma_f32_32x32x16_bf16 v[48:63], a[0:3], v[80:83], 0
    s_waitcnt lgkmcnt(6)
    v_mfma_f32_32x32x16_bf16 v[48:63], a[4:7], v[84:87], v[48:63]
    s_waitcnt lgkmcnt(5)
    v_mfma_f32_32x32x16_bf16 v[48:63], a[8:11], v[88:91], v[48:63]
    s_waitcnt lgkmcnt(4)
    v_mfma_f32_32x32x16_bf16 v[48:63], a[12:15], v[92:95], v[48:63]
    s_waitcnt vmcnt(8)
    s_barrier
    ds_read_b128 v[80:83], v13 offset:16384
    ds_read_b128 v[84:87], v14 offset:16384
    ds_read_b128 v[88:91], v15 offset:16384
    ds_read_b128 v[92:95], v16 offset:16384
    s_waitcnt lgkmcnt(7)
    v_mfma_f32_32x32x16_bf16 v[48:63], a[16:19], v[96:99], v[48:63]
    s_waitcnt lgkmcnt(6)
    v_mfma_f32_32x32x16_bf16 v[48:63], a[20:23], v[100:103], v[48:63]
    s_waitcnt lgkmcnt(5)
    v_mfma_f32_32x32x16_bf16 v[48:63], a[24:27], v[104:107], v[48:63]
    s_waitcnt lgkmcnt(4)
    v_mfma_f32_32x32x16_bf16 v[48:63], a[28:31], v[108:111], v[48:63]
    ds_read_b128 v[96:99], v13 offset:24576
    ds_read_b128 v[100:103], v14 offset:24576
    ds_read_b128 v[104:107], v15 offset:24576
    ds_read_b128 v[108:111], v16 offset:24576
    s_waitcnt lgkmcnt(7)
    v_mfma_f32_32x32x16_bf16 v[48:63], a[32:35], v[80:83], v[48:63]
    s_waitcnt lgkmcnt(6)
    v_mfma_f32_32x32x16_bf16 v[48:63], a[36:39], v[84:87], v[48:63]
    s_waitcnt lgkmcnt(5)
    v_mfma_f32_32x32x16_bf16 v[48:63], a[40:43], v[88:91], v[48:63]
    s_waitcnt lgkmcnt(4)
    v_mfma_f32_32x32x16_bf16 v[48:63], a[44:47], v[92:95], v[48:63]
    s_waitcnt vmcnt(4)
    s_barrier
    ds_read_b128 v[80:83], v13 offset:32768
    ds_read_b128 v[84:87], v14 offset:32768
    ds_read_b128 v[88:91], v15 offset:32768
    ds_read_b128 v[92:95], v16 offset:32768
    s_waitcnt lgkmcnt(7)
    v_mfma_f32_32x32x16_bf16 v[48:63], a[48:51], v[96:99], v[48:63]
    s_waitcnt lgkmcnt(6)
    v_mfma_f32_32x32x16_bf16 v[48:63], a[52:55], v[100:103], v[48:63]
    s_waitcnt lgkmcnt(5)
    v_mfma_f32_32x32x16_bf16 v[48:63], a[56:59], v[104:107], v[48:63]
    s_waitcnt lgkmcnt(4)
    v_mfma_f32_32x32x16_bf16 v[48:63], a[60:63], v[108:111], v[48:63]
    ds_read_b128 v[96:99], v13 offset:40960
    ds_read_b128 v[100:103], v14 offset:40960
    ds_read_b128 v[104:107], v15 offset:40960
    ds_read_b128 v[108:111], v16 offset:40960
    s_waitcnt lgkmcnt(7)
    v_mfma_f32_32x32x16_bf16 v[48:63], a[64:67], v[80:83], v[48:63]
    s_waitcnt lgkmcnt(6)
    v_mfma_f32_32x32x16_bf16 v[48:63], a[68:71], v[84:87], v[48:63]
    s_waitcnt lgkmcnt(5)
    v_mfma_f32_32x32x16_bf16 v[48:63], a[72:75], v[88:91], v[48:63]
    s_waitcnt lgkmcnt(4)
    v_mfma_f32_32x32x16_bf16 v[48:63], a[76:79], v[92:95], v[48:63]
    s_waitcnt vmcnt(0)
    s_barrier
    ds_read_b128 v[80:83], v13 offset:49152
    ds_read_b128 v[84:87], v14 offset:49152
    ds_read_b128 v[88:91], v15 offset:49152
    ds_read_b128 v[92:95], v16 offset:49152
    s_waitcnt lgkmcnt(7)
    v_mfma_f32_32x32x16_bf16 v[48:63], a[80:83], v[96:99], v[48:63]
    s_waitcnt lgkmcnt(6)
    v_mfma_f32_32x32x16_bf16 v[48:63], a[84:87], v[100:103], v[48:63]
    s_waitcnt lgkmcnt(5)
    v_mfma_f32_32x32x16_bf16 v[48:63], a[88:91], v[104:107], v[48:63]
    s_waitcnt lgkmcnt(4)
    v_mfma_f32_32x32x16_bf16 v[48:63], a[92:95], v[108:111], v[48:63]
    ds_read_b128 v[96:99], v13 offset:57344
    ds_read_b128 v[100:103], v14 offset:57344
    ds_read_b128 v[104:107], v15 offset:57344
    ds_read_b128 v[108:111], v16 offset:57344
    s_waitcnt lgkmcnt(7)
    v_mfma_f32_32x32x16_bf16 v[48:63], a[96:99], v[80:83], v[48:63]
    s_waitcnt lgkmcnt(6)
    v_mfma_f32_32x32x16_bf16 v[48:63], a[100:103], v[84:87], v[48:63]
    s_waitcnt lgkmcnt(5)
    v_mfma_f32_32x32x16_bf16 v[48:63], a[104:107], v[88:91], v[48:63]
    s_waitcnt lgkmcnt(4)
    v_mfma_f32_32x32x16_bf16 v[48:63], a[108:111], v[92:95], v[48:63]
    s_waitcnt lgkmcnt(3)
    v_mfma_f32_32x32x16_bf16 v[48:63], a[112:115], v[96:99], v[48:63]
    s_waitcnt lgkmcnt(2)
    v_mfma_f32_32x32x16_bf16 v[48:63], a[116:119], v[100:103], v[48:63]
    s_waitcnt lgkmcnt(1)
    v_mfma_f32_32x32x16_bf16 v[48:63], a[120:123], v[104:107], v[48:63]
    s_waitcnt lgkmcnt(0)
    v_mfma_f32_32x32x16_bf16 v[48:63], a[124:127], v[108:111], v[48:63]
    s_nop 11
    v_cvt_pk_bf16_f32 v112, v48, v49
    v_cvt_pk_bf16_f32 v113, v50, v51
    v_cvt_pk_bf16_f32 v114, v52, v53
    v_cvt_pk_bf16_f32 v115, v54, v55
    v_cvt_pk_bf16_f32 v116, v56, v57
    v_cvt_pk_bf16_f32 v117, v58, v59
    v_cvt_pk_bf16_f32 v118, v60, v61
    v_cvt_pk_bf16_f32 v119, v62, v63
    v_permlane32_swap_b32 v112, v114
    v_permlane32_swap_b32 v113, v115
    v_permlane32_swap_b32 v116, v118
    v_permlane32_swap_b32 v117, v119
    buffer_store_dwordx4 v[112:115], v17, s[48:51], s100 offen offset:0
    buffer_store_dwordx4 v[116:119], v17, s[48:51], s100 offen offset:32
    s_endpgm
L_roleB:
    s_sub_u32 s9, s2, 256
    s_and_b32 s4, s9, 7
    s_lshr_b32 s5, s9, 3
    s_lshr_b32 s7, s5, 2
    s_lshl_b32 s61, s4, 3
    s_add_u32 s61, s61, s7
    s_and_b32 s62, s5, 3
    s_lshl_b32 s70, s3, 13
    s_lshl_b32 s63, s61, 10
    s_lshl_b32 s6, s3, 19
    s_add_u32 s63, s63, s6
    v_lshlrev_b32 v23, 4, v1
    s_lshl_b32 s68, s5, 17
    s_sub_u32 s6, 7, s4
    s_min_u32 s6, s6, s4
    s_lshl_b32 s6, s6, 7
    s_add_u32 s68, s68, s6
    s_lshr_b32 s6, s4, 2
    s_lshl_b32 s6, s6, 6
    s_add_u32 s68, s68, s6
    s_add_u32 s68, s68, s70
    s_add_u32 s68, s68, 0
    s_mov_b32 s67, 7348224
    s_lshl_b32 s6, s11, 10
    s_add_u32 s6, s6, s5
    s_lshl_b32 s69, s6, 11
    s_lshl_b32 s6, s4, 7
    s_add_u32 s69, s69, s6
    s_lshl_b32 s6, s10, 6
    s_add_u32 s69, s69, s6
    s_add_u32 s69, s69, 1024
    s_lshl_b32 s64, s61, 11
    s_lshl_b32 s7, s62, 9
    s_add_u32 s64, s64, s7
    s_lshl_b32 s7, s3, 7
    s_add_u32 s64, s64, s7
    s_add_u32 s64, s64, 0
    s_lshl_b32 s66, s9, 2
    s_add_u32 s66, s66, 7348224
    v_and_b32 v40, 15, v1
    v_lshrrev_b32 v41, 4, v1
    v_lshrrev_b32 v42, 1, v40
    v_lshrrev_b32 v44, 5, v1
    v_and_b32 v50, 7, v1
    v_lshrrev_b32 v54, 3, v1
    v_lshlrev_b32 v50, 4, v50
    v_lshl_add_u32 v16, v54, 17, v50
    v_mov_b32 v56, -1
    v_mov_b32 v57, -1
    v_mov_b32 v58, -1
    v_mov_b32 v59, -1
    s_waitcnt lgkmcnt(0)
    s_mov_b32 s28, s80
    s_mov_b32 s29, s81
    s_mov_b32 s30, 2097152
    s_mov_b32 s31, 0x00020000
    s_mov_b32 s48, s90
    s_mov_b32 s49, s91
    s_mov_b32 s50, 4194304
    s_mov_b32 s51, 0x00020000
    s_mov_b32 s52, s92
    s_mov_b32 s53, s93
    s_mov_b32 s54, 256
    s_mov_b32 s55, 0x00020000
    s_mov_b32 s56, s94
    s_mov_b32 s57, s95
    s_mov_b32 s58, 16777216
    s_mov_b32 s59, 0x00020000
    s_lshl_b32 s6, s62, 2
    s_add_u32 s6, s6, 1
    v_add_u32 v43, s6, v42
    v_cmp_gt_u32 vcc, 4, v42
    s_nop 1
    v_cndmask_b32 v43, 0, v43, vcc
    v_cvt_f32_u32 v43, v43
    v_mul_f32 v46, 0x3d000000, v43
    v_cvt_f32_u32 v49, v41
    v_and_b32 v50, 1, v1
    v_cvt_f32_u32 v50, v50
    v_mul_f32 v50, 0x3e800000, v50
    v_mul_f32 v49, 4.0, v49
    v_fma_f32 v45, v49, v46, v50
    v_mul_f32 v47, 0x41500000, v46
    v_cos_f32 v60, v45
    v_add_f32 v45, v45, v46
    v_cos_f32 v61, v45
    v_add_f32 v45, v45, v46
    v_cos_f32 v62, v45
    v_add_f32 v45, v45, v46
    v_cos_f32 v63, v45
    v_add_f32 v45, v45, v47
    v_cos_f32 v64, v45
    v_add_f32 v45, v45, v46
    v_cos_f32 v65, v45
    v_add_f32 v45, v45, v46
    v_cos_f32 v66, v45
    v_add_f32 v45, v45, v46
    v_cos_f32 v67, v45
    v_cvt_pk_bf16_f32 v24, v60, v61
    v_cvt_pk_bf16_f32 v25, v62, v63
    v_cvt_pk_bf16_f32 v26, v64, v65
    v_cvt_pk_bf16_f32 v27, v66, v67
    s_add_u32 s7, s6, s3
    v_lshlrev_b32 v49, 5, v40
    v_add_u32 v49, s7, v49
    v_cvt_f32_u32 v49, v49
    v_mul_f32 v46, 0x3b000000, v49
    v_bfe_u32 v48, v1, 4, 1
    v_cvt_f32_u32 v48, v48
    v_mul_f32 v48, 0x3e800000, v48
    v_cvt_f32_u32 v50, v44
    v_mul_f32 v50, 0x41000000, v50
    s_mul_i32 s7, s10, 0x40800000
    v_add_f32 v51, s7, v50
    v_fma_f32 v45, v51, v46, v48
    s_cmp_eq_u32 s10, 1
    s_cselect_b32 s7, 0xc0e00000, 1.0
    v_mul_f32 v47, s7, v46
    v_add_f32 v51, 0xbe800000, v45
    v_cos_f32 v60, v45
    v_add_f32 v45, v45, v46
    v_cos_f32 v61, v45
    v_add_f32 v45, v45, v46
    v_cos_f32 v62, v45
    v_add_f32 v45, v45, v46
    v_cos_f32 v63, v45
    v_add_f32 v45, v45, v47
    v_cos_f32 v64, v45
    v_add_f32 v45, v45, v46
    v_cos_f32 v65, v45
    v_add_f32 v45, v45, v46
    v_cos_f32 v66, v45
    v_add_f32 v45, v45, v46
    v_cos_f32 v67, v45
    v_cvt_pk_bf16_f32 v28, v60, v61
    v_cvt_pk_bf16_f32 v29, v62, v63
    v_cvt_pk_bf16_f32 v30, v64, v65
    v_cvt_pk_bf16_f32 v31, v66, v67
    v_cos_f32 v60, v51
    v_add_f32 v51, v51, v46
    v_cos_f32 v61, v51
    v_add_f32 v51, v51, v46
    v_cos_f32 v62, v51
    v_add_f32 v51, v51, v46
    v_cos_f32 v63, v51
    v_add_f32 v51, v51, v47
    v_cos_f32 v64, v51
    v_add_f32 v51, v51, v46
    v_cos_f32 v65, v51
    v_add_f32 v51, v51, v46
    v_cos_f32 v66, v51
    v_add_f32 v51, v51, v46
    v_cos_f32 v67, v51
    v_cvt_pk_bf16_f32 v32, v60, v61
    v_cvt_pk_bf16_f32 v33, v62, v63
    v_cvt_pk_bf16_f32 v34, v64, v65
    v_cvt_pk_bf16_f32 v35, v66, v67
    v_bfe_u32 v49, v40, 2, 1
    s_lshl_b32 s7, s3, 1
    v_add_u32 v49, s7, v49
    v_sub_u32 v51, 15, v49
    v_and_b32 v52, 1, v40
    v_cmp_eq_u32 vcc, 1, v52
    s_nop 1
    v_cndmask_b32 v49, v49, v51, vcc
    v_cvt_f32_u32 v49, v49
    v_mul_f32 v46, 0x3d800000, v49
    v_fma_f32 v45, v50, v46, v48
    v_cos_f32 v60, v45
    v_add_f32 v45, v45, v46
    v_cos_f32 v61, v45
    v_add_f32 v45, v45, v46
    v_cos_f32 v62, v45
    v_add_f32 v45, v45, v46
    v_cos_f32 v63, v45
    v_add_f32 v45, v45, v46
    v_cos_f32 v64, v45
    v_add_f32 v45, v45, v46
    v_cos_f32 v65, v45
    v_add_f32 v45, v45, v46
    v_cos_f32 v66, v45
    v_add_f32 v45, v45, v46
    v_cos_f32 v67, v45
    v_cvt_pk_bf16_f32 v36, v60, v61
    v_cvt_pk_bf16_f32 v37, v62, v63
    v_cvt_pk_bf16_f32 v38, v64, v65
    v_cvt_pk_bf16_f32 v39, v66, v67
    v_lshrrev_b32 v49, 2, v1
    s_lshl_b32 s7, s10, 10
    s_add_u32 s7, s7, s61
    v_lshl_add_u32 v49, v49, 6, s7
    v_cvt_f32_u32 v49, v49
    v_mul_f32 v46, 0x3a000000, v49
    v_and_b32 v51, 3, v1
    v_lshlrev_b32 v51, 3, v51
    v_cvt_f32_u32 v51, v51
    s_mul_i32 s7, s11, 0x3e800000
    v_mov_b32 v52, s7
    v_fma_f32 v45, v51, v46, v52
    v_cos_f32 v60, v45
    v_add_f32 v45, v45, v46
    v_cos_f32 v61, v45
    v_add_f32 v45, v45, v46
    v_cos_f32 v62, v45
    v_add_f32 v45, v45, v46
    v_cos_f32 v63, v45
    v_add_f32 v45, v45, v46
    v_cos_f32 v64, v45
    v_add_f32 v45, v45, v46
    v_cos_f32 v65, v45
    v_add_f32 v45, v45, v46
    v_cos_f32 v66, v45
    v_add_f32 v45, v45, v46
    v_cos_f32 v67, v45
    v_cvt_pk_bf16_f32 v52, v60, v61
    v_cvt_pk_bf16_f32 v53, v62, v63
    v_cvt_pk_bf16_f32 v54, v64, v65
    v_cvt_pk_bf16_f32 v55, v66, v67
    s_add_u32 s7, s60, 32768
    v_add_u32 v51, s7, v23
    ds_write_b128 v51, v[52:55]
    v_lshrrev_b32 v68, 3, v1
    s_lshl_b32 s6, s3, 3
    v_add_u32 v68, s6, v68
    v_and_b32 v69, 7, v1
    v_lshrrev_b32 v70, 4, v1
    s_lshl_b32 s6, s10, 2
    v_add_u32 v71, s6, v70
    v_xor_b32 v71, v71, v69
    v_lshlrev_b32 v71, 4, v71
    v_and_b32 v70, 1, v70
    v_lshlrev_b32 v70, 2, v70
    v_xor_b32 v70, v70, v69
    v_cvt_f32_u32 v49, v68
    v_mul_f32 v46, 0x3c800000, v49
    v_lshrrev_b32 v49, 1, v71
    v_cvt_f32_u32 v49, v49
    s_mov_b32 s7, 0x80000000
    v_mul_f32 v45, v49, v46
    v_cos_f32 v60, v45
    v_add_f32 v45, v45, v46
    v_cos_f32 v61, v45
    v_add_f32 v45, v45, v46
    v_cos_f32 v62, v45
    v_add_f32 v45, v45, v46
    v_cos_f32 v63, v45
    v_add_f32 v45, v45, v46
    v_cos_f32 v64, v45
    v_add_f32 v45, v45, v46
    v_cos_f32 v65, v45
    v_add_f32 v45, v45, v46
    v_cos_f32 v66, v45
    v_add_f32 v45, v45, v46
    v_cos_f32 v67, v45
    v_cvt_pk_bf16_f32 v52, v60, v61
    v_cvt_pk_bf16_f32 v53, v62, v63
    v_cvt_pk_bf16_f32 v54, v64, v65
    v_cvt_pk_bf16_f32 v55, v66, v67
    ds_write_b128 v51, v[52:55] offset:4096
    v_xor_b32 v56, s7, v52
    v_xor_b32 v57, s7, v53
    v_xor_b32 v58, s7, v54
    v_xor_b32 v59, s7, v55
    ds_write_b128 v51, v[56:59] offset:8192
    v_mov_b32 v50, 0x3e800000
    v_fma_f32 v45, v49, v46, v50
    v_cos_f32 v60, v45
    v_add_f32 v45, v45, v46
    v_cos_f32 v61, v45
    v_add_f32 v45, v45, v46
    v_cos_f32 v62, v45
    v_add_f32 v45, v45, v46
    v_cos_f32 v63, v45
    v_add_f32 v45, v45, v46
    v_cos_f32 v64, v45
    v_add_f32 v45, v45, v46
    v_cos_f32 v65, v45
    v_add_f32 v45, v45, v46
    v_cos_f32 v66, v45
    v_add_f32 v45, v45, v46
    v_cos_f32 v67, v45
    v_cvt_pk_bf16_f32 v52, v60, v61
    v_cvt_pk_bf16_f32 v53, v62, v63
    v_cvt_pk_bf16_f32 v54, v64, v65
    v_cvt_pk_bf16_f32 v55, v66, v67
    ds_write_b128 v51, v[52:55] offset:12288
    v_xor_b32 v56, s7, v52
    v_xor_b32 v57, s7, v53
    v_xor_b32 v58, s7, v54
    v_xor_b32 v59, s7, v55
    ds_write_b128 v51, v[56:59] offset:16384
    v_xor_b32 v49, v40, v41
    v_lshrrev_b32 v50, 2, v49
    v_and_b32 v49, 3, v49
    v_lshlrev_b32 v49, 4, v49
    v_lshl_add_u32 v49, v50, 9, v49
    v_lshl_add_u32 v15, v41, 11, v49
    v_lshlrev_b32 v2, 3, v1
    v_add_u32 v2, s70, v2
    v_lshlrev_b32 v3, 11, v42
    v_lshrrev_b32 v48, 4, v1
    v_lshrrev_b32 v49, 1, v1
    v_xor_b32 v48, v48, v49
    v_and_b32 v48, 1, v48
    v_lshl_add_u32 v3, v48, 3, v3
    v_lshrrev_b32 v49, 3, v1
    v_xor_b32 v48, v49, v1
    v_and_b32 v48, 4, v48
    v_lshl_add_u32 v3, v48, 2, v3
    v_and_b32 v49, 1, v49
    v_lshl_add_u32 v3, v49, 6, v3
    v_xor_b32 v48, s10, v1
    v_and_b32 v48, 1, v48
    v_lshl_add_u32 v3, v48, 5, v3
    s_lshl_b32 s6, s3, 9
    s_add_u32 s6, s6, 53248
    v_add_u32 v3, s6, v3
    v_xor_b32 v96, 64, v3
    v_xor_b32 v97, 16, v3
    v_xor_b32 v98, 0x50, v3
    v_and_b32 v48, 31, v1
    v_bfe_u32 v49, v1, 2, 2
    v_xor_b32 v49, v49, v44
    v_lshlrev_b32 v49, 4, v49
    v_lshl_add_u32 v49, v48, 6, v49
    s_lshl_b32 s6, s11, 4
    v_xor_b32 v4, s6, v49
    s_lshl_b32 s6, s3, 11
    s_add_u32 s7, s6, 53248
    v_add_u32 v4, s7, v4
    v_xor_b32 v124, 32, v4
    v_xor_b32 v5, 64, v49
    v_add_u32 v5, 61440, v5
    v_bfe_u32 v49, v1, 1, 2
    v_xor_b32 v49, v49, v44
    v_xor_b32 v49, s3, v49
    v_lshlrev_b32 v49, 4, v49
    v_lshl_add_u32 v49, v48, 6, v49
    v_add_u32 v6, s6, v49
    v_xor_b32 v125, 32, v6
    v_bfe_u32 v50, v1, 2, 1
    s_lshl_b32 s6, s3, 1
    v_add_u32 v50, s6, v50
    v_sub_u32 v51, 15, v50
    v_bfe_u32 v52, v1, 3, 1
    v_cmp_eq_u32 vcc, 1, v52
    s_nop 1
    v_cndmask_b32 v50, v50, v51, vcc
    v_and_b32 v51, 16, v1
    v_add_u32 v50, v50, v51
    v_bfe_u32 v52, v50, 1, 2
    v_lshlrev_b32 v50, 6, v50
    v_and_b32 v51, 3, v1
    v_lshl_add_u32 v50, v51, 11, v50
    v_xor_b32 v52, v52, v51
    v_xor_b32 v52, v52, v44
    v_lshl_add_u32 v7, v52, 4, v50
    v_xor_b32 v126, 32, v7
    v_lshlrev_b32 v50, 2, v44
    v_bfe_u32 v51, v1, 2, 2
    v_add_u32 v50, v50, v51
    v_lshlrev_b32 v50, 6, v50
    v_bfe_u32 v52, v1, 4, 1
    v_lshl_add_u32 v50, v52, 5, v50
    v_and_b32 v53, 3, v1
    v_lshl_add_u32 v50, v53, 3, v50
    v_add_u32 v8, 32768, v50
    v_and_b32 v50, 7, v1
    v_xor_b32 v54, v50, v44
    v_lshlrev_b32 v54, 4, v54
    v_lshl_add_u32 v9, v48, 7, v54
    s_lshl_b32 s6, s3, 12
    s_add_u32 s6, s6, 8192
    v_add_u32 v9, s6, v9
    v_lshrrev_b32 v54, 3, v1
    v_xor_b32 v55, v50, v54
    v_lshlrev_b32 v55, 4, v55
    v_lshl_add_u32 v10, v54, 7, v55
    v_add_u32 v10, s6, v10
    v_lshlrev_b32 v22, 16, v48
    v_lshl_add_u32 v22, v44, 4, v22
    v_lshlrev_b32 v50, 3, v44
    v_add_u32 v50, v50, v51
    v_lshlrev_b32 v50, 8, v50
    v_and_b32 v54, 1, v1
    v_lshlrev_b32 v54, 1, v54
    v_bfe_u32 v55, v1, 1, 1
    v_add_u32 v54, v54, v55
    v_sub_u32 v55, 3, v54
    v_cmp_eq_u32 vcc, 1, v52
    s_nop 1
    v_cndmask_b32 v54, v54, v55, vcc
    v_lshlrev_b32 v54, 6, v54
    v_lshl_add_u32 v54, v52, 3, v54
    v_xor_b32 v55, s10, v51
    v_lshl_add_u32 v54, v55, 4, v54
    v_add_u32 v21, v50, v54
    v_add_u32 v21, 65536, v21
    v_and_b32 v48, 31, v1
    v_lshlrev_b32 v48, 7, v48
    v_lshrrev_b32 v49, 5, v1
    v_bfe_u32 v50, v1, 1, 3
    v_xor_b32 v49, v49, v50
    v_lshl_add_u32 v48, v49, 4, v48
    s_lshl_b32 s6, s11, 12
    s_add_u32 s6, s6, 36864
    v_xor_b32 v49, 0, v48
    v_add_u32 v17, s6, v49
    v_xor_b32 v49, 32, v48
    v_add_u32 v18, s6, v49
    v_xor_b32 v49, 64, v48
    v_add_u32 v19, s6, v49
    v_xor_b32 v49, 96, v48
    v_add_u32 v20, s6, v49
    v_lshlrev_b32 v12, 4, v1
    s_add_u32 s6, s60, 65536
    v_add_u32 v13, s6, v23
    s_add_u32 s8, s63, 0
    s_add_u32 m0, s70, 0
    s_nop 0
    buffer_load_dwordx4 v23, s[28:31], s8 offen lds
    s_add_u32 s8, s63, 65536
    s_add_u32 m0, s70, 1024
    s_nop 0
    buffer_load_dwordx4 v23, s[28:31], s8 offen lds
    s_add_u32 s8, s63, 131072
    s_add_u32 m0, s70, 2048
    s_nop 0
    buffer_load_dwordx4 v23, s[28:31], s8 offen lds
    s_add_u32 s8, s63, 196608
    s_add_u32 m0, s70, 3072
    s_nop 0
    buffer_load_dwordx4 v23, s[28:31], s8 offen lds
    s_add_u32 s8, s63, 262144
    s_add_u32 m0, s70, 4096
    s_nop 0
    buffer_load_dwordx4 v23, s[28:31], s8 offen lds
    s_add_u32 s8, s63, 327680
    s_add_u32 m0, s70, 5120
    s_nop 0
    buffer_load_dwordx4 v23, s[28:31], s8 offen lds
    s_add_u32 s8, s63, 393216
    s_add_u32 m0, s70, 6144
    s_nop 0
    buffer_load_dwordx4 v23, s[28:31], s8 offen lds
    s_add_u32 s8, s63, 458752
    s_add_u32 m0, s70, 7168
    s_nop 0
    buffer_load_dwordx4 v23, s[28:31], s8 offen lds
    s_waitcnt vmcnt(0)
    ds_read_b64_tr_b16 v[64:65], v2 offset:0
    ds_read_b64_tr_b16 v[66:67], v2 offset:512
    ds_read_b64_tr_b16 v[68:69], v2 offset:1024
    ds_read_b64_tr_b16 v[70:71], v2 offset:1536
    ds_read_b64_tr_b16 v[72:73], v2 offset:2048
    ds_read_b64_tr_b16 v[74:75], v2 offset:2560
    ds_read_b64_tr_b16 v[76:77], v2 offset:3072
    ds_read_b64_tr_b16 v[78:79], v2 offset:3584
    ds_read_b64_tr_b16 v[80:81], v2 offset:4096
    ds_read_b64_tr_b16 v[82:83], v2 offset:4608
    ds_read_b64_tr_b16 v[84:85], v2 offset:5120
    ds_read_b64_tr_b16 v[86:87], v2 offset:5632
    ds_read_b64_tr_b16 v[88:89], v2 offset:6144
    ds_read_b64_tr_b16 v[90:91], v2 offset:6656
    ds_read_b64_tr_b16 v[92:93], v2 offset:7168
    ds_read_b64_tr_b16 v[94:95], v2 offset:7680
    s_waitcnt lgkmcnt(14)
    v_mfma_f32_16x16x32_bf16 v[40:43], v[64:67], v[24:27], 0
    s_waitcnt lgkmcnt(12)
    v_mfma_f32_16x16x32_bf16 v[44:47], v[68:71], v[24:27], 0
    s_waitcnt lgkmcnt(10)
    v_mfma_f32_16x16x32_bf16 v[48:51], v[72:75], v[24:27], 0
    s_waitcnt lgkmcnt(8)
    v_mfma_f32_16x16x32_bf16 v[52:55], v[76:79], v[24:27], 0
    s_nop 1
    v_cvt_pk_bf16_f32 v56, v40, v41
    v_cvt_pk_bf16_f32 v57, v42, v43
    ds_write_b64 v3, v[56:57] offset:0
    v_cvt_pk_bf16_f32 v58, v44, v45
    v_cvt_pk_bf16_f32 v59, v46, v47
    ds_write_b64 v96, v[58:59] offset:0
    v_cvt_pk_bf16_f32 v60, v48, v49
    v_cvt_pk_bf16_f32 v61, v50, v51
    ds_write_b64 v3, v[60:61] offset:128
    v_cvt_pk_bf16_f32 v62, v52, v53
    v_cvt_pk_bf16_f32 v63, v54, v55
    ds_write_b64 v96, v[62:63] offset:128
    s_waitcnt lgkmcnt(4)
    v_mfma_f32_16x16x32_bf16 v[40:43], v[80:83], v[24:27], 0
    v_mfma_f32_16x16x32_bf16 v[44:47], v[84:87], v[24:27], 0
    v_mfma_f32_16x16x32_bf16 v[48:51], v[88:91], v[24:27], 0
    v_mfma_f32_16x16x32_bf16 v[52:55], v[92:95], v[24:27], 0
    s_nop 4
    v_cvt_pk_bf16_f32 v56, v40, v41
    v_cvt_pk_bf16_f32 v57, v42, v43
    ds_write_b64 v97, v[56:57] offset:256
    v_cvt_pk_bf16_f32 v58, v44, v45
    v_cvt_pk_bf16_f32 v59, v46, v47
    ds_write_b64 v98, v[58:59] offset:256
    v_cvt_pk_bf16_f32 v60, v48, v49
    v_cvt_pk_bf16_f32 v61, v50, v51
    ds_write_b64 v97, v[60:61] offset:384
    v_cvt_pk_bf16_f32 v62, v52, v53
    v_cvt_pk_bf16_f32 v63, v54, v55
    ds_write_b64 v98, v[62:63] offset:384
    s_waitcnt lgkmcnt(0)
    s_barrier
    buffer_load_dword v11, off, s[52:55], 0 sc1
    ds_read_b128 v[112:115], v4
    ds_read_b128 v[116:119], v124
    ds_read_b128 v[120:123], v5
    ds_read_b64_tr_b16 v[40:41], v8 offset:0
    ds_read_b64_tr_b16 v[42:43], v8 offset:512
    ds_read_b64_tr_b16 v[44:45], v8 offset:1024
    ds_read_b64_tr_b16 v[46:47], v8 offset:1536
    ds_read_b64_tr_b16 v[48:49], v8 offset:2048
    ds_read_b64_tr_b16 v[50:51], v8 offset:2560
    ds_read_b64_tr_b16 v[52:53], v8 offset:3072
    ds_read_b64_tr_b16 v[54:55], v8 offset:3584
    s_waitcnt lgkmcnt(9)
    v_mfma_f32_32x32x16_bf16 v[64:79], v[112:115], v[28:31], 0
    v_mfma_f32_32x32x16_bf16 v[64:79], v[116:119], v[32:35], v[64:79]
    s_waitcnt lgkmcnt(8)
    v_mfma_f32_32x32x16_bf16 v[80:95], v[120:123], v[36:39], 0
    s_nop 9
    v_cvt_pk_bf16_f32 v96, v64, v65
    v_cvt_pk_bf16_f32 v97, v66, v67
    v_cvt_pk_bf16_f32 v98, v68, v69
    v_cvt_pk_bf16_f32 v99, v70, v71
    v_cvt_pk_bf16_f32 v100, v72, v73
    v_cvt_pk_bf16_f32 v101, v74, v75
    v_cvt_pk_bf16_f32 v102, v76, v77
    v_cvt_pk_bf16_f32 v103, v78, v79
    ds_write_b128 v6, v[96:99]
    ds_write_b128 v125, v[100:103]
    v_cvt_pk_bf16_f32 v104, v80, v81
    v_cvt_pk_bf16_f32 v105, v82, v83
    v_cvt_pk_bf16_f32 v106, v84, v85
    v_cvt_pk_bf16_f32 v107, v86, v87
    v_cvt_pk_bf16_f32 v108, v88, v89
    v_cvt_pk_bf16_f32 v109, v90, v91
    v_cvt_pk_bf16_f32 v110, v92, v93
    v_cvt_pk_bf16_f32 v111, v94, v95
    s_waitcnt lgkmcnt(0)
    s_barrier
    ds_read_b128 v[112:115], v7
    ds_read_b128 v[116:119], v126
    v_mfma_f32_32x32x16_bf16 a[0:15], v[104:107], v[40:43], 0
    v_mfma_f32_32x32x16_bf16 a[16:31], v[104:107], v[48:51], 0
    v_mfma_f32_32x32x16_bf16 a[0:15], v[108:111], v[44:47], a[0:15]
    v_mfma_f32_32x32x16_bf16 a[16:31], v[108:111], v[52:55], a[16:31]
    s_waitcnt lgkmcnt(0)
    v_mfma_f32_32x32x16_bf16 v[64:79], v[112:115], v[40:43], 0
    v_mfma_f32_32x32x16_bf16 v[80:95], v[112:115], v[48:51], 0
    v_mfma_f32_32x32x16_bf16 v[64:79], v[116:119], v[44:47], v[64:79]
    v_mfma_f32_32x32x16_bf16 v[80:95], v[116:119], v[52:55], v[80:95]
    s_nop 5
    v_accvgpr_read_b32 v24, a0
    v_accvgpr_read_b32 v25, a1
    v_accvgpr_read_b32 v26, a8
    v_accvgpr_read_b32 v27, a9
    v_accvgpr_read_b32 v28, a16
    v_accvgpr_read_b32 v29, a17
    v_accvgpr_read_b32 v30, a24
    v_accvgpr_read_b32 v31, a25
    v_sub_f32 v32, v24, v30
    v_sub_f32 v33, v25, v31
    v_sub_f32 v34, -v28, v26
    v_sub_f32 v35, -v29, v27
    v_sub_f32 v96, v64, v88
    v_sub_f32 v104, -v80, v72
    v_add_f32 v47, v64, v88
    v_sub_f32 v55, v72, v80
    v_sub_f32 v40, v68, v92
    v_sub_f32 v48, -v84, v76
    v_add_f32 v103, v68, v92
    v_sub_f32 v111, v76, v84
    v_sub_f32 v97, v65, v89
    v_sub_f32 v105, -v81, v73
    v_add_f32 v46, v65, v89
    v_sub_f32 v54, v73, v81
    v_sub_f32 v41, v69, v93
    v_sub_f32 v49, -v85, v77
    v_add_f32 v102, v69, v93
    v_sub_f32 v110, v77, v85
    v_sub_f32 v98, v66, v90
    v_sub_f32 v106, -v82, v74
    v_add_f32 v45, v66, v90
    v_sub_f32 v53, v74, v82
    v_sub_f32 v42, v70, v94
    v_sub_f32 v50, -v86, v78
    v_add_f32 v101, v70, v94
    v_sub_f32 v109, v78, v86
    v_sub_f32 v99, v67, v91
    v_sub_f32 v107, -v83, v75
    v_add_f32 v44, v67, v91
    v_sub_f32 v52, v75, v83
    v_sub_f32 v43, v71, v95
    v_sub_f32 v51, -v87, v79
    v_add_f32 v100, v71, v95
    v_sub_f32 v108, v79, v87
    s_cmp_eq_u32 s62, 3
    s_cselect_b64 vcc, -1, 0
    v_cndmask_b32 v100, v100, v32, vcc
    v_cndmask_b32 v44, v44, v33, vcc
    v_cndmask_b32 v108, v108, v34, vcc
    v_cndmask_b32 v52, v52, v35, vcc
    v_cvt_pk_bf16_f32 v64, v96, v97
    v_cvt_pk_bf16_f32 v65, v98, v99
    v_cvt_pk_bf16_f32 v66, v100, v101
    v_cvt_pk_bf16_f32 v67, v102, v103
    v_min_u32 v64, 0xfffffffe, v64
    v_min_u32 v65, 0xfffffffe, v65
    v_min_u32 v66, 0xfffffffe, v66
    v_min_u32 v67, 0xfffffffe, v67
    ds_write_b128 v9, v[64:67]
    v_cvt_pk_bf16_f32 v68, v104, v105
    v_cvt_pk_bf16_f32 v69, v106, v107
    v_cvt_pk_bf16_f32 v70, v108, v109
    v_cvt_pk_bf16_f32 v71, v110, v111
    v_min_u32 v68, 0xfffffffe, v68
    v_min_u32 v69, 0xfffffffe, v69
    v_min_u32 v70, 0xfffffffe, v70
    v_min_u32 v71, 0xfffffffe, v71
    v_xor_b32 v57, 32, v9
    ds_write_b128 v57, v[68:71]
    v_cvt_pk_bf16_f32 v72, v40, v41
    v_cvt_pk_bf16_f32 v73, v42, v43
    v_cvt_pk_bf16_f32 v74, v44, v45
    v_cvt_pk_bf16_f32 v75, v46, v47
    v_min_u32 v72, 0xfffffffe, v72
    v_min_u32 v73, 0xfffffffe, v73
    v_min_u32 v74, 0xfffffffe, v74
    v_min_u32 v75, 0xfffffffe, v75
    v_xor_b32 v58, 80, v9
    ds_write_b128 v58, v[72:75]
    v_cvt_pk_bf16_f32 v76, v48, v49
    v_cvt_pk_bf16_f32 v77, v50, v51
    v_cvt_pk_bf16_f32 v78, v52, v53
    v_cvt_pk_bf16_f32 v79, v54, v55
    v_min_u32 v76, 0xfffffffe, v76
    v_min_u32 v77, 0xfffffffe, v77
    v_min_u32 v78, 0xfffffffe, v78
    v_min_u32 v79, 0xfffffffe, v79
    v_xor_b32 v59, 112, v9
    ds_write_b128 v59, v[76:79]
    s_waitcnt lgkmcnt(0)
    ds_read_b128 v[80:83], v10 offset:0
    ds_read_b128 v[84:87], v10 offset:1024
    ds_read_b128 v[88:91], v10 offset:2048
    ds_read_b128 v[92:95], v10 offset:3072
    s_waitcnt lgkmcnt(3)
    buffer_store_dwordx4 v[80:83], v16, s[56:59], s64 offen sc1
    s_waitcnt lgkmcnt(2)
    s_add_u32 s8, s64, 1048576
    buffer_store_dwordx4 v[84:87], v16, s[56:59], s8 offen sc1
    s_waitcnt lgkmcnt(1)
    s_add_u32 s8, s64, 2097152
    buffer_store_dwordx4 v[88:91], v16, s[56:59], s8 offen sc1
    s_waitcnt lgkmcnt(0)
    s_add_u32 s8, s64, 3145728
    buffer_store_dwordx4 v[92:95], v16, s[56:59], s8 offen sc1
    s_waitcnt vmcnt(4)
    v_cmp_ne_u32 vcc, 0, v11
    s_cmp_eq_u64 vcc, exec
    s_cbranch_scc1 L_nonce_ok_B
    v_mov_b32 v40, 0
    s_mov_b32 s9, 0
L_nonce_B:
    buffer_load_dword v11, v40, s[52:55], 0 offen sc1
    s_add_u32 s9, s9, 1
    s_waitcnt vmcnt(0)
    v_cmp_ne_u32 vcc, 0, v11
    s_cmp_gt_u32 s9, 200000
    s_cbranch_scc1 L_nonce_B_x
    s_cmp_eq_u64 vcc, exec
    s_cbranch_scc0 L_nonce_B
L_nonce_B_x:
L_nonce_ok_B:
    s_waitcnt vmcnt(0)
    s_barrier
    s_cmp_lg_u32 s3, 0
    s_cbranch_scc1 L_B_nopub
    v_mov_b32 v40, 0
    s_mov_b64 exec, 1
    buffer_store_dword v11, v40, s[56:59], s66 offen sc1
    s_mov_b64 exec, -1
    s_cmp_lg_u32 s2, 256
    s_cbranch_scc1 L_B_noagg
    v_lshlrev_b32 v60, 4, v1
    s_mov_b32 s9, 0
L_poll_b:
    buffer_load_dwordx4 v[40:43], v60, s[56:59], s67 offen sc1
    s_add_u32 s9, s9, 1
    s_waitcnt vmcnt(0)
    v_xor_b32 v40, v40, v11
    v_xor_b32 v41, v41, v11
    v_or_b32 v40, v40, v41
    v_xor_b32 v42, v42, v11
    v_or_b32 v40, v40, v42
    v_xor_b32 v43, v43, v11
    v_or_b32 v40, v40, v43
    v_cmp_eq_u32 vcc, 0, v40
    s_cmp_gt_u32 s9, 200000
    s_cbranch_scc1 L_poll_b_x
    s_cmp_eq_u64 vcc, exec
    s_cbranch_scc1 L_poll_b_x
    s_sleep 4
    s_branch L_poll_b
L_poll_b_x:
    v_mul_u32_u24 v40, 4224, v1
    s_mov_b32 s8, 8388608
    buffer_store_dword v11, v40, s[56:59], s8 offen sc1
    s_mov_b32 s8, 8658944
    buffer_store_dword v11, v40, s[56:59], s8 offen sc1
    s_mov_b32 s8, 8929280
    buffer_store_dword v11, v40, s[56:59], s8 offen sc1
    s_mov_b32 s8, 9199616
    buffer_store_dword v11, v40, s[56:59], s8 offen sc1
L_B_noagg:
    s_sub_u32 s8, s2, 256
    s_mul_i32 s8, s8, 4224
    s_add_u32 s8, s8, 8388608
    v_mov_b32 v44, 0
    s_mov_b32 s9, 0
L_poll_go:
    buffer_load_dword v40, v44, s[56:59], s8 offen sc1
    s_add_u32 s9, s9, 1
    s_waitcnt vmcnt(0)
    v_cmp_eq_u32 vcc, v40, v11
    s_cmp_gt_u32 s9, 200000
    s_cbranch_scc1 L_poll_go_x
    s_cmp_eq_u64 vcc, exec
    s_cbranch_scc1 L_poll_go_x
    s_sleep 4
    s_branch L_poll_go
L_poll_go_x:
L_B_nopub:
    s_barrier
    s_add_u32 m0, s60, 65536
    s_nop 0
    buffer_load_dwordx4 v15, s[56:59], s68 offen sc1 lds
    s_add_u32 s8, s68, 32768
    s_add_u32 m0, s60, 69632
    s_nop 0
    buffer_load_dwordx4 v15, s[56:59], s8 offen sc1 lds
    s_add_u32 s8, s68, 65536
    s_add_u32 m0, s60, 73728
    s_nop 0
    buffer_load_dwordx4 v15, s[56:59], s8 offen sc1 lds
    s_add_u32 s8, s68, 98304
    s_add_u32 m0, s60, 77824
    s_nop 0
    buffer_load_dwordx4 v15, s[56:59], s8 offen sc1 lds
    v_xor_b32 v40, 32, v21
    s_waitcnt vmcnt(3)
    s_barrier
    ds_read_b64_tr_b16 a[0:1], v21 offset:0
    ds_read_b64_tr_b16 a[2:3], v21 offset:1024
    ds_read_b128 a[4:7], v17 offset:0
    ds_read_b64_tr_b16 a[16:17], v40 offset:0
    ds_read_b64_tr_b16 a[18:19], v40 offset:1024
    ds_read_b128 a[20:23], v17 offset:8192
    s_waitcnt lgkmcnt(3)
    v_mfma_f32_32x32x16_bf16 v[64:79], a[0:3], a[4:7], 0
    s_waitcnt lgkmcnt(0)
    v_mfma_f32_32x32x16_bf16 v[64:79], a[16:19], a[20:23], v[64:79]
    s_waitcnt vmcnt(2)
    s_barrier
    ds_read_b64_tr_b16 a[0:1], v21 offset:4096
    ds_read_b64_tr_b16 a[2:3], v21 offset:5120
    ds_read_b128 a[4:7], v18 offset:0
    ds_read_b64_tr_b16 a[16:17], v40 offset:4096
    ds_read_b64_tr_b16 a[18:19], v40 offset:5120
    ds_read_b128 a[20:23], v18 offset:8192
    s_waitcnt lgkmcnt(3)
    v_mfma_f32_32x32x16_bf16 v[64:79], a[0:3], a[4:7], v[64:79]
    s_waitcnt lgkmcnt(0)
    v_mfma_f32_32x32x16_bf16 v[64:79], a[16:19], a[20:23], v[64:79]
    s_waitcnt vmcnt(1)
    s_barrier
    ds_read_b64_tr_b16 a[0:1], v21 offset:8192
    ds_read_b64_tr_b16 a[2:3], v21 offset:9216
    ds_read_b128 a[4:7], v19 offset:0
    ds_read_b64_tr_b16 a[16:17], v40 offset:8192
    ds_read_b64_tr_b16 a[18:19], v40 offset:9216
    ds_read_b128 a[20:23], v19 offset:8192
    s_waitcnt lgkmcnt(3)
    v_mfma_f32_32x32x16_bf16 v[64:79], a[0:3], a[4:7], v[64:79]
    s_waitcnt lgkmcnt(0)
    v_mfma_f32_32x32x16_bf16 v[64:79], a[16:19], a[20:23], v[64:79]
    s_waitcnt vmcnt(0)
    s_barrier
    ds_read_b64_tr_b16 a[0:1], v21 offset:12288
    ds_read_b64_tr_b16 a[2:3], v21 offset:13312
    ds_read_b128 a[4:7], v20 offset:0
    ds_read_b64_tr_b16 a[16:17], v40 offset:12288
    ds_read_b64_tr_b16 a[18:19], v40 offset:13312
    ds_read_b128 a[20:23], v20 offset:8192
    s_waitcnt lgkmcnt(3)
    v_mfma_f32_32x32x16_bf16 v[64:79], a[0:3], a[4:7], v[64:79]
    s_waitcnt lgkmcnt(0)
    v_mfma_f32_32x32x16_bf16 v[64:79], a[16:19], a[20:23], v[64:79]
    s_nop 11
    v_mov_b32 v40, v71
    v_mov_b32 v41, v71
    s_nop 1
    v_permlane32_swap_b32 v40, v41
    v_cmp_le_u32 vcc, 32, v1
    s_nop 1
    v_cndmask_b32 v42, v72, v40, vcc
    v_cndmask_b32 v43, v41, v72, vcc
    v_cvt_pk_bf16_f32 v48, v42, v64
    v_cvt_pk_bf16_f32 v49, v65, v66
    v_cvt_pk_bf16_f32 v50, v67, v68
    v_cvt_pk_bf16_f32 v51, v69, v70
    buffer_store_dwordx4 v[48:51], v22, s[48:51], s69 offen offset:0
    v_cvt_pk_bf16_f32 v52, v43, v73
    v_cvt_pk_bf16_f32 v53, v74, v75
    v_cvt_pk_bf16_f32 v54, v76, v77
    v_cvt_pk_bf16_f32 v55, v78, v79
    buffer_store_dwordx4 v[52:55], v22, s[48:51], s69 offen offset:32
L_end:
    s_endpgm
.section .rodata,"a"
.p2align 6
.amdhsa_kernel concat_heads__linear_kernel_hedgehog__spectral_fnet__prompt_kernel
  .amdhsa_next_free_vgpr 256
  .amdhsa_next_free_sgpr 102
  .amdhsa_accum_offset 128
  .amdhsa_group_segment_fixed_size 0
  .amdhsa_kernarg_size 96
  .amdhsa_user_sgpr_count 2
  .amdhsa_user_sgpr_kernarg_segment_ptr 1
  .amdhsa_system_sgpr_workgroup_id_x 1
.end_amdhsa_kernel
```
